```python
import torch

def _softmax(x, axis=-1):
    return torch.softmax(x, dim=axis)
def _gelu(x):
    return torch.nn.functional.gelu(x, approximate="tanh")
def _silu(x):
    return torch.nn.functional.silu(x)
def _sigmoid(x):
    return torch.sigmoid(x)
def _layernorm(x, axis=-1, eps=1e-5):
    m = x.mean(dim=axis, keepdim=True)
    v = x.var(dim=axis, keepdim=True, unbiased=False)
    return (x - m) / torch.sqrt(v + eps)
def _scatter_add(tgt, idx, src, axis=0):
    return tgt.clone().index_add_(axis, idx, src)
def _segment_sum(src, seg, n):
    out = torch.zeros((n,) + src.shape[1:], dtype=src.dtype)
    return out.index_add_(0, seg, src)
def _pad(x, pw):
    flat = tuple(v for pair in reversed(pw) for v in pair)
    return torch.nn.functional.pad(x, flat)

kernel_name = 'standalone__mpnn_edge_mlp__graph'

def setup_inputs():

    _w = (lambda a: (lambda t: t.to(torch.bfloat16) if t.is_floating_point() else t)(torch.as_tensor(a)))
    N, deg, D, De = 10000, 16, 256, max(4, 1)
    E = N * deg
    return {
        "x": _w((lambda *s: torch.randn(*s, dtype=torch.bfloat16) * 0.05)(N, D)),
        "e_attr": _w((lambda *s: torch.randn(*s, dtype=torch.bfloat16) * 0.4)(E, De)),
        "src": _w((lambda lo, hi, *s: torch.randint(lo, hi, s))(0, N, E).to(torch.int64)),
        "dst": _w((lambda lo, hi, *s: torch.randint(lo, hi, s))(0, N, E).to(torch.int64)),
        "w_msg": _w((lambda *s: torch.randn(*s, dtype=torch.bfloat16) * 0.4)(2 * D + De, D)),
        "w_upd": _w((lambda *s: torch.randn(*s, dtype=torch.bfloat16) * 0.05)(2 * D, D)),
    }

def reference(x, e_attr, src, dst, w_msg, w_upd):
    N, D = x.shape
    m_in = torch.concatenate([x[src], x[dst], e_attr], axis=-1)
    msg = _silu(m_in @ w_msg)
    agg = _segment_sum(msg, dst, N)
    return _silu(torch.concatenate([x, agg], axis=-1) @ w_upd)
```

```asm
; @launch grid=(256,1,1) block=(512,1,1) lds=152832
.amdgcn_target "amdgcn-amd-amdhsa--gfx950"
.text
.globl standalone__mpnn_edge_mlp__graph_kernel
.p2align 8
.type standalone__mpnn_edge_mlp__graph_kernel,@function
standalone__mpnn_edge_mlp__graph_kernel:
FK_START:
    s_cmp_ge_u32 s2, 256
    s_cbranch_scc1 K2_END
    s_load_dwordx16 s[16:31], s[0:1], 0
    s_load_dwordx2 s[14:15], s[0:1], 64
    s_getpc_b64 s[64:65]
FK_PC:
    s_sub_u32 s64, s64, FK_PC-FK_START
    s_subb_u32 s65, s65, 0
    s_and_b32 s66, s2, 0xf8
    v_add_u32 v121, s66, v0
    v_lshlrev_b32 v121, 7, v121
    v_min_u32 v121, (FK_CODE_END-FK_START-4)&0xffffff80, v121
    v_cmp_gt_u32 vcc, 8, v0
    s_and_saveexec_b64 s[66:67], vcc
    s_cbranch_execz FK_NOPF
    global_load_dword v121, v121, s[64:65]
FK_NOPF:
    s_mov_b64 exec, -1
    v_and_b32 v1, 63, v0
    v_lshrrev_b32 v4, 6, v0
    v_lshrrev_b32 v5, 5, v1
    v_readfirstlane_b32 s3, v4
    v_and_b32 v6, 31, v1
    v_lshlrev_b32 v2, 4, v1
    s_and_b32 s52, s3, 3
    s_lshr_b32 s53, s3, 2
    s_lshl_b32 s63, s3, 14
    s_lshl_b32 s55, s3, 13
    s_add_u32 s56, s55, 4096
    s_lshr_b32 s64, s2, 3
    s_mul_i32 s66, s64, 11
    s_lshr_b32 s66, s66, 5
    s_mul_i32 s65, s66, 3
    s_sub_u32 s80, s64, s65
    s_and_b32 s67, s2, 7
    v_lshrrev_b32 v7, 3, v1
    v_lshrrev_b32 v8, 4, v1
    v_and_b32 v9, 7, v1
    v_xor_b32 v8, v8, v9
    v_lshlrev_b32 v7, 9, v7
    v_lshl_add_u32 v27, v8, 4, v7
    v_xor_b32 v28, 64, v27
    s_cmp_eq_u32 s80, 2
    s_cbranch_scc1 FK_HELP
    s_mul_i32 s64, s66, 24
    s_add_u32 s64, s64, s67
    s_xor_b32 s70, s2, 0
    s_lshl_b32 s65, s80, 3
    s_sub_u32 s71, s64, s65
    s_add_u32 s71, s71, 8
    s_add_u32 s72, s64, 16
    s_cmp_lt_u32 s70, 256
    s_cselect_b32 s73, 1, 0
    s_cselect_b32 s70, s70, s64
    s_mul_i32 s70, s70, 625
    s_lshr_b32 s70, s70, 4
    s_lshl_b32 s70, s70, 9
    s_add_u32 s70, s70, 20480
    s_cmp_lt_u32 s71, 256
    s_cselect_b32 s74, 1, 0
    s_cselect_b32 s71, s71, s64
    s_mul_i32 s71, s71, 625
    s_lshr_b32 s71, s71, 4
    s_lshl_b32 s71, s71, 9
    s_cmp_lt_u32 s72, 256
    s_cselect_b32 s75, 1, 0
    s_cselect_b32 s72, s72, s64
    s_mul_i32 s72, s72, 625
    s_lshr_b32 s72, s72, 4
    s_lshl_b32 s72, s72, 9
    s_sub_u32 s72, s72, 20480
    v_lshrrev_b32 v4, 4, v1
    v_and_b32 v7, 15, v1
    v_lshlrev_b32 v8, 2, v4
    v_xor_b32 v7, v7, v8
    v_lshlrev_b32 v8, 9, v4
    v_lshl_add_u32 v21, v7, 4, v8
    s_lshl_b32 s64, s80, 8
    s_lshl_b32 s65, s3, 12
    s_add_u32 s64, s64, s65
    v_add_u32 v21, s64, v21
    v_add_u32 v22, 2048, v21
    s_lshl_b32 s69, s3, 11
    s_lshl_b32 s64, s3, 1
    s_cmp_lt_u32 s64, 10
    s_cselect_b32 s82, s71, s72
    s_cmp_lt_u32 s64, 5
    s_cselect_b32 s82, s70, s82
    s_lshl_b32 s64, s64, 10
    s_lshl_b32 s65, s64, 2
    s_add_u32 s82, s82, s65
    s_cmp_lt_u32 s3, 3
    s_mov_b32 s65, 65536
    s_cselect_b32 s65, s65, 83968
    s_add_u32 s60, s64, s65
    s_lshl_b32 s64, s3, 1
    s_add_u32 s64, s64, 1
    s_cmp_lt_u32 s64, 10
    s_cselect_b32 s83, s71, s72
    s_cmp_lt_u32 s64, 5
    s_cselect_b32 s83, s70, s83
    s_lshl_b32 s64, s64, 10
    s_lshl_b32 s65, s64, 2
    s_add_u32 s83, s83, s65
    s_cmp_lt_u32 s3, 3
    s_mov_b32 s65, 65536
    s_cselect_b32 s65, s65, 83968
    s_add_u32 s61, s64, s65
    s_cmp_lt_u32 s3, 3
    s_movk_i32 s65, 10240
    s_cselect_b32 s68, 6144, s65
    s_lshl_b32 s64, s80, 1
    s_add_u32 s57, s66, s64
    s_and_b32 s57, s57, 3
    s_mov_b32 s58, s57
    s_waitcnt lgkmcnt(0)
    s_mov_b64 s[4:5], s[16:17]
    s_mov_b64 s[6:7], s[18:19]
    s_mov_b64 s[36:37], s[20:21]
    s_mov_b64 s[38:39], s[22:23]
    s_mov_b64 s[8:9], s[24:25]
    s_mov_b64 s[10:11], s[26:27]
    s_mov_b64 s[40:41], s[28:29]
    s_mov_b64 s[42:43], s[30:31]
    s_mov_b64 s[12:13], s[42:43]
    s_add_u32 s20, s14, 0xf00000
    s_addc_u32 s21, s15, 0
    s_mov_b32 s22, 0x6000
    s_mov_b32 s23, 0x20000
    s_and_b32 s64, s2, 31
    s_lshl_b32 s64, s64, 8
    v_lshl_add_u32 v123, v0, 13, s64
    buffer_load_dword v122, v123, s[20:23], 0 offen sc0 sc1
    s_sub_u32 s16, s4, 0x5000
    s_subb_u32 s17, s5, 0
    s_mov_b32 s18, 0x4e7000
    s_mov_b32 s19, 0x20000
    s_mov_b32 s24, s8
    s_mov_b32 s25, s9
    s_mov_b32 s26, 0x40800
    s_mov_b32 s27, 0x20000
    s_mul_i32 s65, s58, s68
    s_lshl_b32 s59, s58, 7
    s_add_u32 m0, s60, s65
    s_add_u32 s64, s82, s59
    buffer_load_dwordx4 v27, s[16:19], s64 offen nt lds
    s_add_u32 m0, s61, s65
    s_add_u32 s64, s83, s59
    buffer_load_dwordx4 v28, s[16:19], s64 offen nt lds
    s_add_u32 m0, s69, 0
    s_lshl_b32 s64, s58, 15
    s_add_u32 s58, s58, 1
    s_and_b32 s58, s58, 3
    buffer_load_dwordx4 v21, s[24:27], s64 offen lds
    s_add_u32 m0, s69, 1024
    s_nop 0
    buffer_load_dwordx4 v22, s[24:27], s64 offen lds
    v_mov_b32 v228, 0
    v_mov_b32 v229, 0
    v_mov_b32 v230, 0
    v_mov_b32 v231, 10000
    v_lshlrev_b32 v236, 4, v0
    v_add_u32 v236, 133120, v236
    s_cmp_eq_u32 s3, 0
    s_cselect_b32 s64, 90112, 0
    s_cmp_eq_u32 s3, 1
    s_cselect_b32 s64, 131200, s64
    v_mov_b32 v232, s64
    v_mov_b32 v233, s64
    v_mov_b32 v234, s64
    v_mov_b32 v235, s64
    v_cmp_gt_u32 vcc, 240, v0
    ds_write_b128 v236, v[228:231]
    s_mov_b64 exec, vcc
    ds_write_b128 v236, v[232:235] offset:15872
    s_mov_b64 exec, -1
    v_cmp_gt_u32 vcc, 480, v0
    s_mov_b64 exec, vcc
    ds_write_b128 v236, v[228:231] offset:8192
    s_mov_b64 exec, -1
    s_mov_b32 s32, s40
    s_mov_b32 s33, s41
    s_mov_b32 s34, 0x4e2000
    s_mov_b32 s35, 0x20000
    s_add_u32 s28, s14, 0xe00000
    s_addc_u32 s29, s15, 0
    s_mov_b32 s30, 0x61000
    s_mov_b32 s31, 0x20000
    s_mov_b32 s36, s14
    s_mov_b32 s37, s15
    s_or_b32 s37, s37, 0x2000000
    s_mov_b32 s38, 0x4e3200
    s_mov_b32 s39, 0x20000
    s_sub_u32 s40, s14, 0x400
    s_subb_u32 s41, s15, 0
    s_or_b32 s41, s41, 0x2000000
    s_mov_b32 s42, 0x4e3200
    s_mov_b32 s43, 0x20000
    s_sub_u32 s44, s14, 0x800
    s_subb_u32 s45, s15, 0
    s_or_b32 s45, s45, 0x2000000
    s_mov_b32 s46, 0x4e3200
    s_mov_b32 s47, 0x20000
    s_sub_u32 s48, s14, 0xc00
    s_subb_u32 s49, s15, 0
    s_or_b32 s49, s49, 0x2000000
    s_mov_b32 s50, 0x4e3200
    s_mov_b32 s51, 0x20000
    v_and_b32 v15, 7, v1
    v_lshrrev_b32 v16, 4, v1
    v_xor_b32 v15, v15, v16
    s_lshl_b32 s64, s52, 7
    v_lshl_add_u32 v141, v15, 4, s64
    v_xor_b32 v143, 64, v141
    v_mov_b32 v145, v141
    v_mov_b32 v147, v143
    v_bfe_u32 v15, v1, 3, 2
    v_lshlrev_b32 v15, 4, v15
    v_add_u32 v159, 133132, v15
    v_and_b32 v15, 1, v1
    v_lshlrev_b32 v15, 4, v15
    v_mov_b32 v16, 0x3f80
    v_lshlrev_b32 v15, v15, v16
    v_lshlrev_b32 v16, 3, v5
    v_sub_u32 v16, v6, v16
    v_ashrrev_i32 v16, 1, v16
    v_cmp_eq_u32 s[16:17], 0, v16
    v_cmp_eq_u32 s[18:19], 1, v16
    v_cmp_eq_u32 s[20:21], 2, v16
    v_cmp_eq_u32 s[22:23], 3, v16
    v_cndmask_b32 v132, 0, v15, s[16:17]
    v_cndmask_b32 v133, 0, v15, s[18:19]
    v_cndmask_b32 v134, 0, v15, s[20:21]
    v_cndmask_b32 v135, 0, v15, s[22:23]
    v_cmp_eq_u32 s[16:17], 8, v16
    v_cmp_eq_u32 s[18:19], 9, v16
    v_cmp_eq_u32 s[20:21], 10, v16
    v_cmp_eq_u32 s[22:23], 11, v16
    v_cndmask_b32 v136, 0, v15, s[16:17]
    v_cndmask_b32 v137, 0, v15, s[18:19]
    v_cndmask_b32 v138, 0, v15, s[20:21]
    v_cndmask_b32 v139, 0, v15, s[22:23]
    v_lshrrev_b32 v16, 2, v6
    v_and_b32 v15, 1, v16
    v_lshlrev_b32 v15, 4, v15
    v_mov_b32 v17, 0x3f80
    v_lshlrev_b32 v15, v15, v17
    v_lshlrev_b32 v17, 2, v5
    v_sub_u32 v16, v16, v17
    v_ashrrev_i32 v16, 1, v16
    v_cmp_eq_u32 s[16:17], 0, v16
    v_cmp_eq_u32 s[18:19], 1, v16
    s_nop 0
    v_cndmask_b32 v152, 0, v15, s[16:17]
    v_cndmask_b32 v153, 0, v15, s[18:19]
    v_bfe_u32 v15, v1, 1, 3
    v_xor_b32 v15, v15, v5
    v_lshl_add_u32 v16, v6, 7, s55
    v_xor_b32 v17, 0, v15
    v_lshl_add_u32 v148, v17, 4, v16
    v_xor_b32 v17, 2, v15
    v_lshl_add_u32 v149, v17, 4, v16
    v_xor_b32 v17, 4, v15
    v_lshl_add_u32 v150, v17, 4, v16
    v_xor_b32 v17, 6, v15
    v_lshl_add_u32 v151, v17, 4, v16
    s_lshl_b32 s64, s52, 7
    v_lshl_add_u32 v167, v6, 2, s64
    v_bfe_u32 v15, v1, 4, 1
    v_lshl_add_u32 v165, v15, 5, s64
    v_and_b32 v15, 3, v1
    v_lshl_add_u32 v165, v15, 3, v165
    v_add_u32 v166, 64, v165
    v_lshrrev_b32 v15, 3, v6
    v_and_b32 v16, 3, v1
    v_lshl_add_u32 v15, v15, 2, v16
    v_lshlrev_b32 v15, 4, v15
    v_add_u32 v158, 133120, v15
    v_bfe_u32 v15, v1, 3, 1
    v_lshl_add_u32 v15, v5, 1, v15
    v_lshlrev_b32 v15, 2, v15
    v_add_u32 v160, 148992, v15
    v_mov_b32 v124, 0
    v_mov_b32 v125, 0
    v_mov_b32 v126, 0
    v_mov_b32 v127, 0
    s_cmp_eq_u32 s53, 0
    s_cbranch_scc1 FK_ES0
    v_lshrrev_b32 v7, 3, v1
    v_bfe_u32 v8, v1, 4, 1
    v_lshlrev_b32 v8, 1, v8
    v_and_b32 v9, 7, v1
    v_xor_b32 v8, v8, v9
    s_lshl_b32 s64, s52, 7
    s_add_u32 s64, s64, 131072
    v_lshl_add_u32 v7, v7, 9, s64
    v_lshl_add_u32 v124, v8, 4, v7
    v_xor_b32 v125, 64, v124
    v_add_u32 v125, 3072, v125
    v_add_u32 v126, 6144, v124
    v_add_u32 v127, 6144, v125
    s_lshl_b32 s64, s52, 13
    v_and_b32 v8, 15, v1
    v_lshrrev_b32 v9, 4, v1
    v_bfe_u32 v112, v1, 1, 3
    v_xor_b32 v9, v9, v112
    v_lshlrev_b32 v8, 7, v8
    v_add_u32 v8, 65536, v8
    v_lshl_add_u32 v112, v9, 4, v8
    v_xor_b32 v113, 64, v112
    v_lshrrev_b32 v7, 4, v1
    v_bfe_u32 v8, v1, 2, 2
    v_lshl_add_u32 v9, v7, 3, v8
    v_lshl_add_u32 v9, v9, 7, s64
    v_and_b32 v10, 3, v1
    v_lshl_add_u32 v9, v10, 3, v9
    v_and_b32 v7, 1, v7
    v_lshrrev_b32 v8, 1, v8
    v_lshl_add_u32 v7, v7, 1, v8
    v_xor_b32 v8, 0, v7
    v_lshl_add_u32 v114, v8, 5, v9
    v_xor_b32 v8, 1, v7
    v_lshl_add_u32 v115, v8, 5, v9
    v_xor_b32 v8, 2, v7
    v_lshl_add_u32 v116, v8, 5, v9
    v_xor_b32 v8, 3, v7
    v_lshl_add_u32 v117, v8, 5, v9
    v_and_b32 v8, 15, v1
    v_lshrrev_b32 v9, 4, v1
    v_bfe_u32 v10, v1, 2, 2
    v_xor_b32 v9, v9, v10
    s_lshl_b32 s64, s52, 7
    v_lshl_add_u32 v9, v9, 4, s64
    v_and_b32 v10, 3, v8
    v_lshlrev_b32 v10, 6, v10
    v_xor_b32 v9, v9, v10
    v_lshl_add_u32 v9, v8, 9, v9
    v_add_u32 v118, 90112, v9
    v_xor_b32 v119, 64, v118
FK_ES0:
    s_sub_u32 s16, s4, 0x5000
    s_subb_u32 s17, s5, 0
    s_mov_b32 s18, 0x4e7000
    s_mov_b32 s19, 0x20000
    s_lshr_b32 s77, s3, 1
    s_and_b32 s78, s3, 1
    v_lshl_add_u32 v8, s77, 5, v6
    v_cmp_gt_u32 vcc, 48, v8
    v_bfe_u32 v7, v1, 1, 3
    v_xor_b32 v7, v7, v5
    v_mov_b32 v9, 83968
    v_mov_b32 v14, 65536
    v_cndmask_b32_e64 v9, v9, v14, vcc
    v_mov_b32 v20, 10240
    v_mov_b32 v14, 6144
    v_cndmask_b32_e64 v20, v20, v14, vcc
    v_lshl_add_u32 v8, v8, 7, v9
    v_xor_b32 v9, 0, v7
    v_lshl_add_u32 v12, v9, 4, v8
    v_mad_u32_u24 v16, v20, s57, v12
    v_xor_b32 v9, 2, v7
    v_lshl_add_u32 v13, v9, 4, v8
    v_mad_u32_u24 v17, v20, s57, v13
    v_xor_b32 v9, 4, v7
    v_lshl_add_u32 v14, v9, 4, v8
    v_mad_u32_u24 v18, v20, s57, v14
    v_xor_b32 v9, 6, v7
    v_lshl_add_u32 v15, v9, 4, v8
    v_mad_u32_u24 v19, v20, s57, v15
    v_bfe_u32 v7, v1, 2, 2
    v_lshl_add_u32 v8, v5, 3, v7
    v_lshlrev_b32 v8, 8, v8
    v_bfe_u32 v9, v1, 4, 1
    v_lshl_add_u32 v8, v9, 5, v8
    v_and_b32 v9, 3, v1
    v_lshl_add_u32 v8, v9, 3, v8
    s_lshl_b32 s64, s78, 1
    v_xor_b32 v9, s64, v7
    v_lshl_add_u32 v24, v9, 6, v8
    v_xor_b32 v9, 1, v9
    v_lshl_add_u32 v25, v9, 6, v8
    s_lshl_b32 s64, s80, 8
    s_lshl_b32 s65, s78, 7
    s_add_u32 s64, s64, s65
    v_lshl_add_u32 v26, v5, 11, s64
    v_lshl_add_u32 v26, v6, 2, v26
    s_cmp_eq_u32 s73, 0
    s_cselect_b32 s70, 0x7f000000, s70
    s_cmp_eq_u32 s74, 0
    s_cselect_b32 s71, 0x7f000000, s71
    s_cmp_eq_u32 s75, 0
    s_cselect_b32 s72, 0x7f000000, s72
    s_lshl_b32 s65, s77, 2
    s_cmp_lt_u32 s65, 15
    s_cselect_b32 s76, s72, 0x7f000000
    s_cmp_lt_u32 s65, 10
    s_cselect_b32 s76, s71, s76
    s_cmp_lt_u32 s65, 5
    s_cselect_b32 s76, s70, s76
    s_lshl_b32 s64, s65, 12
    s_add_u32 s76, s76, s64
    s_add_u32 s65, s65, 1
    s_cmp_lt_u32 s65, 15
    s_cselect_b32 s77, s72, 0x7f000000
    s_cmp_lt_u32 s65, 10
    s_cselect_b32 s77, s71, s77
    s_cmp_lt_u32 s65, 5
    s_cselect_b32 s77, s70, s77
    s_lshl_b32 s64, s65, 12
    s_add_u32 s77, s77, s64
    s_add_u32 s65, s65, 1
    s_cmp_lt_u32 s65, 15
    s_cselect_b32 s78, s72, 0x7f000000
    s_cmp_lt_u32 s65, 10
    s_cselect_b32 s78, s71, s78
    s_cmp_lt_u32 s65, 5
    s_cselect_b32 s78, s70, s78
    s_lshl_b32 s64, s65, 12
    s_add_u32 s78, s78, s64
    s_add_u32 s65, s65, 1
    s_cmp_lt_u32 s65, 15
    s_cselect_b32 s79, s72, 0x7f000000
    s_cmp_lt_u32 s65, 10
    s_cselect_b32 s79, s71, s79
    s_cmp_lt_u32 s65, 5
    s_cselect_b32 s79, s70, s79
    s_lshl_b32 s64, s65, 12
    s_add_u32 s79, s79, s64
    s_sub_u32 s20, s14, 0x5000
    s_subb_u32 s21, s15, 0
    s_mov_b32 s22, 0x4e7000
    s_mov_b32 s23, 0x20000
    v_mov_b32 v30, 0xbfb8aa3b
    v_mov_b32 v31, 0xbfb8aa3b
    s_mul_i32 s65, s58, s68
    s_lshl_b32 s59, s58, 7
    s_add_u32 m0, s60, s65
    s_add_u32 s64, s82, s59
    buffer_load_dwordx4 v27, s[16:19], s64 offen nt lds
    s_add_u32 m0, s61, s65
    s_add_u32 s64, s83, s59
    buffer_load_dwordx4 v28, s[16:19], s64 offen nt lds
    s_add_u32 m0, s69, 16384
    s_lshl_b32 s64, s58, 15
    s_add_u32 s58, s58, 1
    s_and_b32 s58, s58, 3
    buffer_load_dwordx4 v21, s[24:27], s64 offen lds
    s_add_u32 m0, s69, 17408
    s_nop 0
    buffer_load_dwordx4 v22, s[24:27], s64 offen lds
    s_waitcnt lgkmcnt(0)
    s_waitcnt vmcnt(4)
    s_barrier
    ds_read_b128 v[64:67], v16
    s_add_u32 s57, s57, 1
    s_and_b32 s57, s57, 3
    v_mad_u32_u24 v16, v20, s57, v12
    ds_read_b64_tr_b16 v[80:81], v24 offset:0
    ds_read_b64_tr_b16 v[82:83], v24 offset:1024
    ds_read_b64_tr_b16 v[84:85], v25 offset:0
    ds_read_b64_tr_b16 v[86:87], v25 offset:1024
    ds_read_b128 v[68:71], v17
    v_mad_u32_u24 v17, v20, s57, v13
    ds_read_b64_tr_b16 v[88:89], v24 offset:4096
    ds_read_b64_tr_b16 v[90:91], v24 offset:5120
    ds_read_b64_tr_b16 v[92:93], v25 offset:4096
    ds_read_b64_tr_b16 v[94:95], v25 offset:5120
    ds_read_b128 v[72:75], v18
    v_mad_u32_u24 v18, v20, s57, v14
    ds_read_b64_tr_b16 v[96:97], v24 offset:8192
    ds_read_b64_tr_b16 v[98:99], v24 offset:9216
    ds_read_b64_tr_b16 v[100:101], v25 offset:8192
    ds_read_b64_tr_b16 v[102:103], v25 offset:9216
    ds_read_b128 v[76:79], v19
    v_mad_u32_u24 v19, v20, s57, v15
    ds_read_b64_tr_b16 v[104:105], v24 offset:12288
    ds_read_b64_tr_b16 v[106:107], v24 offset:13312
    ds_read_b64_tr_b16 v[108:109], v25 offset:12288
    ds_read_b64_tr_b16 v[110:111], v25 offset:13312
    s_lshl_b32 s66, s52, 13
    s_mul_i32 s65, s58, s68
    s_lshl_b32 s59, s58, 7
    s_add_u32 m0, s60, s65
    s_add_u32 s64, s82, s59
    buffer_load_dwordx4 v27, s[16:19], s64 offen nt lds
    s_add_u32 m0, s61, s65
    s_add_u32 s64, s83, s59
    buffer_load_dwordx4 v28, s[16:19], s64 offen nt lds
    s_add_u32 m0, s69, 32768
    s_lshl_b32 s64, s58, 15
    s_add_u32 s58, s58, 1
    s_and_b32 s58, s58, 3
    buffer_load_dwordx4 v21, s[24:27], s64 offen lds
    s_add_u32 m0, s69, 33792
    s_nop 0
    buffer_load_dwordx4 v22, s[24:27], s64 offen lds
    s_waitcnt lgkmcnt(10)
    v_mfma_f32_32x32x16_bf16 v[32:47], v[64:67], v[80:83], 0
    v_mfma_f32_32x32x16_bf16 v[48:63], v[64:67], v[84:87], 0
    v_mfma_f32_32x32x16_bf16 v[32:47], v[68:71], v[88:91], v[32:47]
    v_mfma_f32_32x32x16_bf16 v[48:63], v[68:71], v[92:95], v[48:63]
    s_waitcnt lgkmcnt(0)
    s_waitcnt vmcnt(4)
    s_barrier
    v_mfma_f32_32x32x16_bf16 v[32:47], v[72:75], v[96:99], v[32:47]
    ds_read_b128 v[168:171], v16
    s_add_u32 s57, s57, 1
    s_and_b32 s57, s57, 3
    v_mad_u32_u24 v16, v20, s57, v12
    ds_read_b64_tr_b16 v[184:185], v24 offset:16384
    ds_read_b64_tr_b16 v[186:187], v24 offset:17408
    ds_read_b64_tr_b16 v[188:189], v25 offset:16384
    v_mfma_f32_32x32x16_bf16 v[48:63], v[72:75], v[100:103], v[48:63]
    ds_read_b64_tr_b16 v[190:191], v25 offset:17408
    ds_read_b128 v[172:175], v17
    v_mad_u32_u24 v17, v20, s57, v13
    ds_read_b64_tr_b16 v[192:193], v24 offset:20480
    ds_read_b64_tr_b16 v[194:195], v24 offset:21504
    ds_read_b64_tr_b16 v[196:197], v25 offset:20480
    ds_read_b64_tr_b16 v[198:199], v25 offset:21504
    v_mfma_f32_32x32x16_bf16 v[32:47], v[76:79], v[104:107], v[32:47]
    ds_read_b128 v[176:179], v18
    v_mad_u32_u24 v18, v20, s57, v14
    ds_read_b64_tr_b16 v[200:201], v24 offset:24576
    ds_read_b64_tr_b16 v[202:203], v24 offset:25600
    ds_read_b64_tr_b16 v[204:205], v25 offset:24576
    ds_read_b64_tr_b16 v[206:207], v25 offset:25600
    ds_read_b128 v[180:183], v19
    v_mfma_f32_32x32x16_bf16 v[48:63], v[76:79], v[108:111], v[48:63]
    v_mad_u32_u24 v19, v20, s57, v15
    ds_read_b64_tr_b16 v[208:209], v24 offset:28672
    ds_read_b64_tr_b16 v[210:211], v24 offset:29696
    ds_read_b64_tr_b16 v[212:213], v25 offset:28672
    ds_read_b64_tr_b16 v[214:215], v25 offset:29696
    s_waitcnt lgkmcnt(0)
    v_mfma_f32_32x32x16_bf16 v[32:47], v[168:171], v[184:187], v[32:47]
    s_mul_i32 s65, s58, s68
    s_lshl_b32 s59, s58, 7
    s_add_u32 m0, s60, s65
    s_add_u32 s64, s82, s59
    v_mfma_f32_32x32x16_bf16 v[48:63], v[168:171], v[188:191], v[48:63]
    buffer_load_dwordx4 v27, s[16:19], s64 offen nt lds
    s_add_u32 m0, s61, s65
    s_add_u32 s64, s83, s59
    buffer_load_dwordx4 v28, s[16:19], s64 offen nt lds
    v_mfma_f32_32x32x16_bf16 v[32:47], v[172:175], v[192:195], v[32:47]
    s_add_u32 m0, s69, 49152
    s_lshl_b32 s64, s58, 15
    s_add_u32 s58, s58, 1
    s_and_b32 s58, s58, 3
    v_mfma_f32_32x32x16_bf16 v[48:63], v[172:175], v[196:199], v[48:63]
    buffer_load_dwordx4 v21, s[24:27], s64 offen lds
    s_add_u32 m0, s69, 50176
    s_nop 0
    buffer_load_dwordx4 v22, s[24:27], s64 offen lds
    s_waitcnt vmcnt(4)
    s_barrier
    v_mfma_f32_32x32x16_bf16 v[32:47], v[176:179], v[200:203], v[32:47]
    ds_read_b128 v[64:67], v16
    s_add_u32 s57, s57, 1
    s_and_b32 s57, s57, 3
    v_mad_u32_u24 v16, v20, s57, v12
    ds_read_b64_tr_b16 v[80:81], v24 offset:32768
    ds_read_b64_tr_b16 v[82:83], v24 offset:33792
    ds_read_b64_tr_b16 v[84:85], v25 offset:32768
    v_mfma_f32_32x32x16_bf16 v[48:63], v[176:179], v[204:207], v[48:63]
    ds_read_b64_tr_b16 v[86:87], v25 offset:33792
    ds_read_b128 v[68:71], v17
    v_mad_u32_u24 v17, v20, s57, v13
    ds_read_b64_tr_b16 v[88:89], v24 offset:36864
    ds_read_b64_tr_b16 v[90:91], v24 offset:37888
    ds_read_b64_tr_b16 v[92:93], v25 offset:36864
    ds_read_b64_tr_b16 v[94:95], v25 offset:37888
    v_mfma_f32_32x32x16_bf16 v[32:47], v[180:183], v[208:211], v[32:47]
    ds_read_b128 v[72:75], v18
    v_mad_u32_u24 v18, v20, s57, v14
    ds_read_b64_tr_b16 v[96:97], v24 offset:40960
    ds_read_b64_tr_b16 v[98:99], v24 offset:41984
    ds_read_b64_tr_b16 v[100:101], v25 offset:40960
    ds_read_b64_tr_b16 v[102:103], v25 offset:41984
    ds_read_b128 v[76:79], v19
    v_mfma_f32_32x32x16_bf16 v[48:63], v[180:183], v[212:215], v[48:63]
    v_mad_u32_u24 v19, v20, s57, v15
    ds_read_b64_tr_b16 v[104:105], v24 offset:45056
    ds_read_b64_tr_b16 v[106:107], v24 offset:46080
    ds_read_b64_tr_b16 v[108:109], v25 offset:45056
    ds_read_b64_tr_b16 v[110:111], v25 offset:46080
    s_waitcnt lgkmcnt(0)
    s_cmp_eq_u32 s53, 0
    s_cbranch_scc1 FK_MFA
    v_mfma_f32_32x32x16_bf16 v[32:47], v[64:67], v[80:83], v[32:47]
    s_add_u32 m0, s66, 0
    s_mov_b32 s64, 0
    buffer_load_dwordx4 v124, s[24:27], s64 offen offset:0 lds
    v_mfma_f32_32x32x16_bf16 v[48:63], v[64:67], v[84:87], v[48:63]
    buffer_load_dwordx4 v125, s[24:27], s64 offen offset:1024 lds
    buffer_load_dwordx4 v126, s[24:27], s64 offen offset:2048 lds
    buffer_load_dwordx4 v127, s[24:27], s64 offen offset:3072 lds
    v_mfma_f32_32x32x16_bf16 v[32:47], v[68:71], v[88:91], v[32:47]
    s_add_u32 m0, s66, 4096
    s_mov_b32 s64, 16384
    buffer_load_dwordx4 v124, s[24:27], s64 offen offset:0 lds
    v_mfma_f32_32x32x16_bf16 v[48:63], v[68:71], v[92:95], v[48:63]
    buffer_load_dwordx4 v125, s[24:27], s64 offen offset:1024 lds
    buffer_load_dwordx4 v126, s[24:27], s64 offen offset:2048 lds
    buffer_load_dwordx4 v127, s[24:27], s64 offen offset:3072 lds
    s_waitcnt vmcnt(8)
    s_branch FK_MFAD
FK_MFA:
    v_mfma_f32_32x32x16_bf16 v[32:47], v[64:67], v[80:83], v[32:47]
    v_mfma_f32_32x32x16_bf16 v[48:63], v[64:67], v[84:87], v[48:63]
    v_mfma_f32_32x32x16_bf16 v[32:47], v[68:71], v[88:91], v[32:47]
    v_mfma_f32_32x32x16_bf16 v[48:63], v[68:71], v[92:95], v[48:63]
    s_waitcnt vmcnt(0)
FK_MFAD:
    s_barrier
    v_mfma_f32_32x32x16_bf16 v[32:47], v[72:75], v[96:99], v[32:47]
    ds_read_b128 v[168:171], v16
    ds_read_b64_tr_b16 v[184:185], v24 offset:49152
    ds_read_b64_tr_b16 v[186:187], v24 offset:50176
    ds_read_b64_tr_b16 v[188:189], v25 offset:49152
    ds_read_b64_tr_b16 v[190:191], v25 offset:50176
    ds_read_b128 v[172:175], v17
    ds_read_b64_tr_b16 v[192:193], v24 offset:53248
    v_mfma_f32_32x32x16_bf16 v[48:63], v[72:75], v[100:103], v[48:63]
    ds_read_b64_tr_b16 v[194:195], v24 offset:54272
    ds_read_b64_tr_b16 v[196:197], v25 offset:53248
    ds_read_b64_tr_b16 v[198:199], v25 offset:54272
    ds_read_b128 v[176:179], v18
    ds_read_b64_tr_b16 v[200:201], v24 offset:57344
    ds_read_b64_tr_b16 v[202:203], v24 offset:58368
    ds_read_b64_tr_b16 v[204:205], v25 offset:57344
    v_mfma_f32_32x32x16_bf16 v[32:47], v[76:79], v[104:107], v[32:47]
    ds_read_b64_tr_b16 v[206:207], v25 offset:58368
    ds_read_b128 v[180:183], v19
    ds_read_b64_tr_b16 v[208:209], v24 offset:61440
    ds_read_b64_tr_b16 v[210:211], v24 offset:62464
    ds_read_b64_tr_b16 v[212:213], v25 offset:61440
    ds_read_b64_tr_b16 v[214:215], v25 offset:62464
    v_mfma_f32_32x32x16_bf16 v[48:63], v[76:79], v[108:111], v[48:63]
    s_waitcnt lgkmcnt(0)
    s_barrier
    s_cmp_eq_u32 s53, 0
    s_cbranch_scc1 FK_MFB
    v_mfma_f32_32x32x16_bf16 v[32:47], v[168:171], v[184:187], v[32:47]
    s_add_u32 m0, s66, 32768
    s_mov_b32 s64, 32768
    v_mfma_f32_32x32x16_bf16 v[48:63], v[168:171], v[188:191], v[48:63]
    buffer_load_dwordx4 v124, s[24:27], s64 offen offset:0 lds
    buffer_load_dwordx4 v125, s[24:27], s64 offen offset:1024 lds
    v_mfma_f32_32x32x16_bf16 v[32:47], v[172:175], v[192:195], v[32:47]
    buffer_load_dwordx4 v126, s[24:27], s64 offen offset:2048 lds
    buffer_load_dwordx4 v127, s[24:27], s64 offen offset:3072 lds
    v_mfma_f32_32x32x16_bf16 v[48:63], v[172:175], v[196:199], v[48:63]
    s_add_u32 m0, s66, 36864
    s_mov_b32 s64, 49152
    v_mfma_f32_32x32x16_bf16 v[32:47], v[176:179], v[200:203], v[32:47]
    buffer_load_dwordx4 v124, s[24:27], s64 offen offset:0 lds
    buffer_load_dwordx4 v125, s[24:27], s64 offen offset:1024 lds
    v_mfma_f32_32x32x16_bf16 v[48:63], v[176:179], v[204:207], v[48:63]
    buffer_load_dwordx4 v126, s[24:27], s64 offen offset:2048 lds
    buffer_load_dwordx4 v127, s[24:27], s64 offen offset:3072 lds
    v_mfma_f32_32x32x16_bf16 v[32:47], v[180:183], v[208:211], v[32:47]
    v_mfma_f32_32x32x16_bf16 v[48:63], v[180:183], v[212:215], v[48:63]
    s_branch FK_MFBD
FK_MFB:
    v_mfma_f32_32x32x16_bf16 v[32:47], v[168:171], v[184:187], v[32:47]
    v_mfma_f32_32x32x16_bf16 v[48:63], v[168:171], v[188:191], v[48:63]
    v_mfma_f32_32x32x16_bf16 v[32:47], v[172:175], v[192:195], v[32:47]
    v_mfma_f32_32x32x16_bf16 v[48:63], v[172:175], v[196:199], v[48:63]
    v_mfma_f32_32x32x16_bf16 v[32:47], v[176:179], v[200:203], v[32:47]
    v_mfma_f32_32x32x16_bf16 v[48:63], v[176:179], v[204:207], v[48:63]
    v_mfma_f32_32x32x16_bf16 v[32:47], v[180:183], v[208:211], v[32:47]
    v_mfma_f32_32x32x16_bf16 v[48:63], v[180:183], v[212:215], v[48:63]
FK_MFBD:
    s_nop 7
    s_nop 2
    v_pk_mul_f32 v[32:33], v[32:33], v[30:31]
    v_pk_mul_f32 v[34:35], v[34:35], v[30:31]
    v_pk_mul_f32 v[36:37], v[36:37], v[30:31]
    v_pk_mul_f32 v[38:39], v[38:39], v[30:31]
    v_pk_mul_f32 v[40:41], v[40:41], v[30:31]
    v_pk_mul_f32 v[42:43], v[42:43], v[30:31]
    v_pk_mul_f32 v[44:45], v[44:45], v[30:31]
    v_pk_mul_f32 v[46:47], v[46:47], v[30:31]
    v_pk_mul_f32 v[48:49], v[48:49], v[30:31]
    v_cvt_pk_bf16_f32 v32, v32, v48
    buffer_store_dword v32, v26, s[20:23], s76 offen offset:0 sc1
    v_cvt_pk_bf16_f32 v33, v33, v49
    buffer_store_dword v33, v26, s[20:23], s76 offen offset:512 sc1
    v_pk_mul_f32 v[50:51], v[50:51], v[30:31]
    v_cvt_pk_bf16_f32 v34, v34, v50
    buffer_store_dword v34, v26, s[20:23], s76 offen offset:1024 sc1
    v_cvt_pk_bf16_f32 v35, v35, v51
    buffer_store_dword v35, v26, s[20:23], s76 offen offset:1536 sc1
    v_pk_mul_f32 v[52:53], v[52:53], v[30:31]
    v_cvt_pk_bf16_f32 v36, v36, v52
    buffer_store_dword v36, v26, s[20:23], s77 offen offset:0 sc1
    v_cvt_pk_bf16_f32 v37, v37, v53
    buffer_store_dword v37, v26, s[20:23], s77 offen offset:512 sc1
    v_pk_mul_f32 v[54:55], v[54:55], v[30:31]
    v_cvt_pk_bf16_f32 v38, v38, v54
    buffer_store_dword v38, v26, s[20:23], s77 offen offset:1024 sc1
    v_cvt_pk_bf16_f32 v39, v39, v55
    buffer_store_dword v39, v26, s[20:23], s77 offen offset:1536 sc1
    v_pk_mul_f32 v[56:57], v[56:57], v[30:31]
    v_cvt_pk_bf16_f32 v40, v40, v56
    buffer_store_dword v40, v26, s[20:23], s78 offen offset:0 sc1
    v_cvt_pk_bf16_f32 v41, v41, v57
    buffer_store_dword v41, v26, s[20:23], s78 offen offset:512 sc1
    v_pk_mul_f32 v[58:59], v[58:59], v[30:31]
    v_cvt_pk_bf16_f32 v42, v42, v58
    buffer_store_dword v42, v26, s[20:23], s78 offen offset:1024 sc1
    v_cvt_pk_bf16_f32 v43, v43, v59
    buffer_store_dword v43, v26, s[20:23], s78 offen offset:1536 sc1
    v_pk_mul_f32 v[60:61], v[60:61], v[30:31]
    v_cvt_pk_bf16_f32 v44, v44, v60
    buffer_store_dword v44, v26, s[20:23], s79 offen offset:0 sc1
    v_cvt_pk_bf16_f32 v45, v45, v61
    buffer_store_dword v45, v26, s[20:23], s79 offen offset:512 sc1
    v_pk_mul_f32 v[62:63], v[62:63], v[30:31]
    v_cvt_pk_bf16_f32 v46, v46, v62
    buffer_store_dword v46, v26, s[20:23], s79 offen offset:1024 sc1
    v_cvt_pk_bf16_f32 v47, v47, v63
    buffer_store_dword v47, v26, s[20:23], s79 offen offset:1536 sc1
FK_Z:
    v_lshrrev_b32 v5, 5, v1
    v_and_b32 v6, 31, v1
    v_mov_b32 v92, 152064
    v_mov_b32 v4, 1
    s_cmp_eq_u32 s53, 0
    s_cbranch_scc0 K2_LOADER
    s_cmp_lt_u32 s80, 2
    s_cbranch_scc1 FK_NOHW
    s_mov_b64 exec, 1
    ds_add_u32 v92, v4 offset:272
    s_mov_b64 exec, -1
    v_mov_b32 v84, 0
    v_mov_b32 v85, 0
    v_mov_b32 v86, 0
    v_mov_b32 v87, 0
    v_lshlrev_b32 v88, 4, v0
    v_add_u32 v88, 110592, v88
    ds_write_b128 v88, v[84:87] offset:0
    ds_write_b128 v88, v[84:87] offset:4096
    ds_write_b128 v88, v[84:87] offset:8192
    ds_write_b128 v88, v[84:87] offset:12288
    ds_write_b128 v88, v[84:87] offset:16384
    v_cmp_gt_u32 vcc, 128, v0
    s_mov_b64 exec, vcc
    ds_write_b128 v88, v[84:87] offset:20480
    s_mov_b64 exec, -1
    s_mov_b32 s65, 4194304
FK_LWHX:
    ds_read_b32 v11, v92 offset:284
    s_sub_u32 s65, s65, 1
    s_cbranch_scc1 FK_LWXHX
    s_waitcnt lgkmcnt(0)
    v_readfirstlane_b32 s64, v11
    s_cmp_lt_u32 s64, 1
    s_cbranch_scc1 FK_LWHX
FK_LWXHX:
    s_cmp_eq_u32 s3, 0
    s_cbranch_scc0 FK_POLLSR
    s_add_u32 s24, s14, 0xf00000
    s_addc_u32 s25, s15, 0
    s_mov_b32 s26, 0x6000
    s_mov_b32 s27, 0x20000
    s_mov_b64 exec, 1
    buffer_load_dword v11, v123, s[24:27], 0 offen sc0 sc1
    s_mov_b64 exec, -1
FK_POLLSR:
    s_branch FK_NOHW2
FK_NOHW:
    s_cmp_eq_u32 s3, 0
    s_cbranch_scc0 FK_POLLSR2
    s_add_u32 s24, s14, 0xf00000
    s_addc_u32 s25, s15, 0
    s_mov_b32 s26, 0x6000
    s_mov_b32 s27, 0x20000
    s_mov_b64 exec, 1
    buffer_load_dword v11, v123, s[24:27], 0 offen sc0 sc1
    s_mov_b64 exec, -1
FK_POLLSR2:
    v_mov_b32 v84, 0
    v_mov_b32 v85, 0
    v_mov_b32 v86, 0
    v_mov_b32 v87, 0
    v_lshlrev_b32 v88, 4, v0
    v_add_u32 v88, 110592, v88
    ds_write_b128 v88, v[84:87] offset:0
    ds_write_b128 v88, v[84:87] offset:4096
    ds_write_b128 v88, v[84:87] offset:8192
    ds_write_b128 v88, v[84:87] offset:12288
    ds_write_b128 v88, v[84:87] offset:16384
    v_cmp_gt_u32 vcc, 128, v0
    s_mov_b64 exec, vcc
    ds_write_b128 v88, v[84:87] offset:20480
    s_mov_b64 exec, -1
    s_cmp_eq_u32 s3, 0
    s_cbranch_scc1 FK_W0
    s_waitcnt vmcnt(0)
FK_W0:
    s_waitcnt vmcnt(1)
    s_mov_b64 exec, 1
    ds_add_u32 v92, v4 offset:272
    s_mov_b64 exec, -1
FK_NOHW2:
    s_lshl_b32 s64, s2, 13
    v_lshrrev_b32 v3, 2, v0
    v_lshl_add_u32 v12, v3, 7, s64
    v_and_b32 v8, 3, v0
    v_lshl_add_u32 v12, v8, 4, v12
    v_lshlrev_b32 v3, 1, v12
    s_cmp_eq_u32 s3, 0
    s_cbranch_scc0 FK_POLLWR
    s_mov_b64 exec, 1
    s_mov_b32 s64, 262144
FK_POLLR:
    s_add_u32 s24, s14, 0xf00000
    s_addc_u32 s25, s15, 0
    s_mov_b32 s26, 0x6000
    s_mov_b32 s27, 0x20000
    s_waitcnt vmcnt(0)
    v_sub_u32 v11, v11, v122
    v_cmp_eq_u32 vcc, 1, v11
    s_cbranch_vccnz FK_POLLXR
    s_sub_u32 s64, s64, 1
    s_cbranch_scc1 FK_POLLXR
    s_and_b32 s65, s64, 15
    s_cbranch_scc0 FK_POLLMR
FK_POLLBR:
    s_sleep 2
    buffer_load_dword v11, v123, s[24:27], 0 offen sc0 sc1
    s_branch FK_POLLR
FK_POLLXR:
    s_mov_b64 exec, 1
    ds_write_b32 v92, v4 offset:276
    s_branch FK_POLLDR
FK_POLLWR:
    s_mov_b32 s65, 4194304
FK_LWPR:
    ds_read_b32 v11, v92 offset:276
    s_sub_u32 s65, s65, 1
    s_cbranch_scc1 FK_LWXPR
    s_waitcnt lgkmcnt(0)
    v_readfirstlane_b32 s64, v11
    s_cmp_lt_u32 s64, 1
    s_cbranch_scc1 FK_LWPR
FK_LWXPR:
FK_POLLDR:
    s_mov_b64 exec, -1
    s_add_u32 s20, s14, 0x600000
    s_addc_u32 s21, s15, 0
    s_mov_b32 s22, 0x200000
    s_mov_b32 s23, 0x20000
    buffer_load_dwordx4 v[76:79], v12, s[20:23], 0 offen
    buffer_load_dwordx4 v[80:83], v12, s[20:23], 0 offen offset:64
    s_waitcnt vmcnt(0)
    v_cmp_le_i32 s[66:67], 0, v76
    v_cmp_le_i32 s[68:69], 0, v77
    v_cmp_le_i32 s[70:71], 0, v78
    v_cmp_le_i32 s[72:73], 0, v79
    v_cmp_le_i32 s[74:75], 0, v80
    v_cmp_le_i32 s[76:77], 0, v81
    v_cmp_le_i32 s[78:79], 0, v82
    v_cmp_le_i32 s[80:81], 0, v83
    v_cmp_eq_u32 vcc, -2, v83
    v_bfe_u32 v28, v76, 14, 6
    v_lshl_add_u32 v28, v28, 2, v92
    s_mov_b64 exec, s[66:67]
    ds_add_rtn_u32 v36, v28, v4
    s_mov_b64 exec, -1
    v_bfe_u32 v29, v77, 14, 6
    v_lshl_add_u32 v29, v29, 2, v92
    s_mov_b64 exec, s[68:69]
    ds_add_rtn_u32 v37, v29, v4
    s_mov_b64 exec, -1
    v_bfe_u32 v30, v78, 14, 6
    v_lshl_add_u32 v30, v30, 2, v92
    s_mov_b64 exec, s[70:71]
    ds_add_rtn_u32 v38, v30, v4
    s_mov_b64 exec, -1
    v_bfe_u32 v31, v79, 14, 6
    v_lshl_add_u32 v31, v31, 2, v92
    s_mov_b64 exec, s[72:73]
    ds_add_rtn_u32 v39, v31, v4
    s_mov_b64 exec, -1
    s_cmp_eq_u64 s[74:75], 0
    s_cbranch_scc1 K2_S1_R
    v_bfe_u32 v32, v80, 14, 6
    v_lshl_add_u32 v32, v32, 2, v92
    s_mov_b64 exec, s[74:75]
    ds_add_rtn_u32 v40, v32, v4
    s_mov_b64 exec, -1
    v_bfe_u32 v33, v81, 14, 6
    v_lshl_add_u32 v33, v33, 2, v92
    s_mov_b64 exec, s[76:77]
    ds_add_rtn_u32 v41, v33, v4
    s_mov_b64 exec, -1
    v_bfe_u32 v34, v82, 14, 6
    v_lshl_add_u32 v34, v34, 2, v92
    s_mov_b64 exec, s[78:79]
    ds_add_rtn_u32 v42, v34, v4
    s_mov_b64 exec, -1
    v_bfe_u32 v35, v83, 14, 6
    v_lshl_add_u32 v35, v35, 2, v92
    s_mov_b64 exec, s[80:81]
    ds_add_rtn_u32 v43, v35, v4
    s_mov_b64 exec, -1
    s_cbranch_vccnz K2_S1_X
K2_S1_R:
    v_lshl_add_u32 v94, v1, 2, v92
    s_cmp_eq_u32 s3, 0
    s_cbranch_scc0 FK_POLLSE
    s_add_u32 s24, s14, 0xf00000
    s_addc_u32 s25, s15, 0
    s_mov_b32 s26, 0x6000
    s_mov_b32 s27, 0x20000
    s_mov_b64 exec, 4
    buffer_load_dword v11, v123, s[24:27], 0 offen sc0 sc1
    s_mov_b64 exec, -1
FK_POLLSE:
    v_mov_b32 v12, -1
    v_and_b32 v13, 0x3fff, v76
    v_mov_b32 v14, -1
    v_and_b32 v15, 0x3fff, v77
    v_mov_b32 v16, -1
    v_and_b32 v17, 0x3fff, v78
    v_mov_b32 v18, -1
    v_and_b32 v19, 0x3fff, v79
    v_mov_b32 v20, -1
    v_and_b32 v21, 0x3fff, v80
    v_mov_b32 v22, -1
    v_and_b32 v23, 0x3fff, v81
    v_mov_b32 v24, -1
    v_and_b32 v25, 0x3fff, v82
    v_mov_b32 v26, -1
    v_and_b32 v27, 0x3fff, v83
    v_lshlrev_b32 v5, 9, v1
    v_and_b32 v7, 15, v1
    v_lshl_add_u32 v6, v7, 4, v5
    v_add_u32 v6, 110592, v6
    v_and_b32 v7, 3, v1
    v_lshl_add_u32 v5, v7, 6, v5
    v_bfe_u32 v7, v1, 2, 2
    v_lshl_add_u32 v5, v7, 4, v5
    v_add_u32 v5, 90112, v5
    s_mov_b64 exec, 1
    s_waitcnt lgkmcnt(0)
    ds_add_u32 v92, v4 offset:260
    s_mov_b32 s65, 4194304
K2_SPINA:
    ds_read_b32 v95, v92 offset:260
    s_sub_u32 s65, s65, 1
    s_cbranch_scc1 K2_SPINXA
    s_waitcnt lgkmcnt(0)
    v_readfirstlane_b32 s64, v95
    s_cmp_lt_u32 s64, 4
    s_cbranch_scc1 K2_SPINA
K2_SPINXA:
    s_mov_b64 exec, -1
    ds_read_b32 v8, v94
    s_waitcnt lgkmcnt(0)
    v_add_u32 v8, 3, v8
    v_lshrrev_b32 v8, 2, v8
    v_mov_b32 v9, v8
    s_nop 1
    v_add_u32_dpp v9, v9, v9 row_shr:1 row_mask:0xf bank_mask:0xf bound_ctrl:0
    s_nop 1
    v_add_u32_dpp v9, v9, v9 row_shr:2 row_mask:0xf bank_mask:0xf bound_ctrl:0
    s_nop 1
    v_add_u32_dpp v9, v9, v9 row_shr:4 row_mask:0xf bank_mask:0xf bound_ctrl:0
    s_nop 1
    v_add_u32_dpp v9, v9, v9 row_shr:8 row_mask:0xf bank_mask:0xf bound_ctrl:0
    s_nop 1
    v_add_u32_dpp v9, v9, v9 row_bcast:15 row_mask:0xa bank_mask:0xf
    s_nop 1
    v_add_u32_dpp v9, v9, v9 row_bcast:31 row_mask:0xc bank_mask:0xf
    v_sub_u32 v10, v9, v8
    v_readlane_b32 s83, v9, 63
    v_lshlrev_b32 v94, 6, v10
    v_add_u32 v94, 133120, v94
    ds_bpermute_b32 v60, v28, v94
    ds_bpermute_b32 v61, v29, v94
    ds_bpermute_b32 v62, v30, v94
    ds_bpermute_b32 v63, v31, v94
    s_cmp_eq_u64 s[74:75], 0
    s_cbranch_scc1 K2_S1_Q
    ds_bpermute_b32 v64, v32, v94
    ds_bpermute_b32 v65, v33, v94
    ds_bpermute_b32 v66, v34, v94
    ds_bpermute_b32 v67, v35, v94
K2_S1_Q:
    s_add_u32 s64, s83, 7
    s_lshr_b32 s64, s64, 3
    s_add_u32 s54, s64, 1
    s_lshr_b32 s54, s54, 1
    s_lshr_b32 s19, s64, 1
    s_mov_b32 s82, 0
    s_cmp_gt_u32 s54, 14
    s_cbranch_scc1 K2_TOOBIG
    s_waitcnt lgkmcnt(0)
    s_mov_b64 exec, s[66:67]
    v_lshl_add_u32 v68, v36, 4, v60
    ds_write_b64 v68, v[12:13] offset:8
    s_mov_b64 exec, s[68:69]
    v_lshl_add_u32 v69, v37, 4, v61
    ds_write_b64 v69, v[14:15] offset:8
    s_mov_b64 exec, s[70:71]
    v_lshl_add_u32 v70, v38, 4, v62
    ds_write_b64 v70, v[16:17] offset:8
    s_mov_b64 exec, s[72:73]
    v_lshl_add_u32 v71, v39, 4, v63
    ds_write_b64 v71, v[18:19] offset:8
    s_cmp_eq_u64 s[74:75], 0
    s_cbranch_scc1 K2_S2_R
    s_mov_b64 exec, s[74:75]
    v_lshl_add_u32 v72, v40, 4, v64
    ds_write_b64 v72, v[20:21] offset:8
    s_mov_b64 exec, s[76:77]
    v_lshl_add_u32 v73, v41, 4, v65
    ds_write_b64 v73, v[22:23] offset:8
    s_mov_b64 exec, s[78:79]
    v_lshl_add_u32 v74, v42, 4, v66
    ds_write_b64 v74, v[24:25] offset:8
    s_mov_b64 exec, s[80:81]
    v_lshl_add_u32 v75, v43, 4, v67
    ds_write_b64 v75, v[26:27] offset:8
K2_S2_R:
    s_mov_b64 exec, -1
    s_cmp_eq_u32 s3, 0
    s_cbranch_scc0 FK_POLLWE
    s_mov_b64 exec, 4
    s_mov_b32 s64, 262144
FK_POLLE:
    s_add_u32 s24, s14, 0xf00000
    s_addc_u32 s25, s15, 0
    s_mov_b32 s26, 0x6000
    s_mov_b32 s27, 0x20000
    s_waitcnt vmcnt(0)
    v_sub_u32 v11, v11, v122
    v_cmp_eq_u32 vcc, 1, v11
    s_cbranch_vccnz FK_POLLXE
    s_sub_u32 s64, s64, 1
    s_cbranch_scc1 FK_POLLXE
    s_and_b32 s65, s64, 15
    s_cbranch_scc0 FK_POLLME
FK_POLLBE:
    s_sleep 2
    buffer_load_dword v11, v123, s[24:27], 0 offen sc0 sc1
    s_branch FK_POLLE
FK_POLLXE:
    s_mov_b64 exec, 1
    ds_write_b32 v92, v4 offset:316
    s_branch FK_POLLDE
FK_POLLWE:
    s_mov_b32 s65, 4194304
FK_LWPE:
    ds_read_b32 v11, v92 offset:316
    s_sub_u32 s65, s65, 1
    s_cbranch_scc1 FK_LWXPE
    s_waitcnt lgkmcnt(0)
    v_readfirstlane_b32 s64, v11
    s_cmp_lt_u32 s64, 1
    s_cbranch_scc1 FK_LWPE
FK_LWXPE:
FK_POLLDE:
    s_mov_b64 exec, -1
    s_add_u32 s24, s14, 0x900000
    s_addc_u32 s25, s15, 0
    s_mov_b32 s26, 0x400000
    s_mov_b32 s27, 0x20000
    buffer_load_dwordx4 v[44:47], v3, s[24:27], 0 offen
    buffer_load_dwordx4 v[48:51], v3, s[24:27], 0 offen offset:16
    s_cmp_eq_u64 s[74:75], 0
    s_cbranch_scc1 FK_E2
    buffer_load_dwordx4 v[52:55], v3, s[24:27], 0 offen offset:128
    buffer_load_dwordx4 v[56:59], v3, s[24:27], 0 offen offset:144
FK_E2:
    s_lshl_b32 s57, s54, 2
    s_lshl_b32 s58, s54, 3
    s_lshl_b32 s65, s19, 2
    s_add_u32 s59, s58, s65
    v_mov_b32 v7, -1
    v_cmp_gt_u32 vcc, s57, v10
    v_cmp_lt_u32 s[20:21], s57, v9
    v_mov_b32 v94, s57
    v_mov_b32 v95, 131728
    s_and_b64 s[20:21], s[20:21], vcc
    s_ff1_i32_b64 s60, s[20:21]
    v_cndmask_b32 v7, v7, v94, s[20:21]
    v_cndmask_b32 v93, v93, v95, s[20:21]
    s_min_u32 s60, s60, 40
    v_cmp_gt_u32 vcc, s58, v10
    v_cmp_lt_u32 s[20:21], s58, v9
    v_mov_b32 v94, s58
    v_mov_b32 v95, 132256
    s_and_b64 s[20:21], s[20:21], vcc
    s_ff1_i32_b64 s61, s[20:21]
    v_cndmask_b32 v7, v7, v94, s[20:21]
    v_cndmask_b32 v93, v93, v95, s[20:21]
    s_min_u32 s61, s61, 40
    v_cmp_gt_u32 vcc, s59, v10
    v_cmp_lt_u32 s[20:21], s59, v9
    v_mov_b32 v94, s59
    v_mov_b32 v95, 132784
    s_and_b64 s[20:21], s[20:21], vcc
    s_ff1_i32_b64 s62, s[20:21]
    v_cndmask_b32 v7, v7, v94, s[20:21]
    v_cndmask_b32 v93, v93, v95, s[20:21]
    s_min_u32 s62, s62, 40
    s_cmp_eq_u32 s60, s61
    s_cselect_b32 s64, 1, 0
    s_cmp_eq_u32 s61, s62
    s_cselect_b32 s64, 1, s64
    s_cmp_eq_u32 s61, 40
    s_cselect_b32 s82, 0, s64
    v_add_u32 v94, s3, v10
    v_lshlrev_b32 v95, 2, v94
    v_add_u32 v95, 148992, v95
    v_cmp_lt_u32 vcc, v94, v9
K2_TLOOP:
    s_mov_b64 exec, vcc
    v_cmp_ge_u32 vcc, v94, v7
    v_cmp_ne_u32 s[20:21], v94, v7
    v_cmp_ne_u32 s[22:23], v94, v10
    ds_write_b32 v95, v5
    v_cndmask_b32_e64 v96, v6, v93, vcc
    s_and_b64 s[20:21], s[20:21], s[22:23]
    v_add_u32 v94, 4, v94
    ds_write_b32 v95, v96 offset:1024
    v_cndmask_b32 v97, 0, 1.0, s[20:21]
    v_cmp_lt_u32 vcc, v94, v9
    ds_write_b32 v95, v97 offset:2048
    v_add_u32 v95, 16, v95
    s_cbranch_vccnz K2_TLOOP
    s_mov_b64 exec, -1
K2_TOOBIG_BACK:
    v_writelane_b32 v8, s54, 0
    v_writelane_b32 v8, s19, 1
    v_writelane_b32 v8, s60, 2
    v_writelane_b32 v8, s61, 3
    v_writelane_b32 v8, s62, 4
    v_writelane_b32 v8, s82, 5
    v_lshl_add_u32 v94, v1, 2, v92
    s_mov_b64 exec, 63
    ds_write_b32 v94, v8 offset:288
    s_mov_b64 exec, -1
    s_waitcnt vmcnt(0)
    s_cmp_eq_u32 s3, 0
    s_cbranch_scc0 FK_POLLSP
    s_add_u32 s24, s14, 0xf00000
    s_addc_u32 s25, s15, 0
    s_mov_b32 s26, 0x6000
    s_mov_b32 s27, 0x20000
    s_mov_b64 exec, 2
    buffer_load_dword v11, v123, s[24:27], 0 offen sc0 sc1
    s_mov_b64 exec, -1
FK_POLLSP:
    s_mov_b64 exec, s[66:67]
    ds_write_b64 v68, v[44:45]
    s_mov_b64 exec, s[68:69]
    ds_write_b64 v69, v[46:47]
    s_mov_b64 exec, s[70:71]
    ds_write_b64 v70, v[48:49]
    s_mov_b64 exec, s[72:73]
    ds_write_b64 v71, v[50:51]
    s_cmp_eq_u64 s[74:75], 0
    s_cbranch_scc1 K2_S3_R
    s_mov_b64 exec, s[74:75]
    ds_write_b64 v72, v[52:53]
    s_mov_b64 exec, s[76:77]
    ds_write_b64 v73, v[54:55]
    s_mov_b64 exec, s[78:79]
    ds_write_b64 v74, v[56:57]
    s_mov_b64 exec, s[80:81]
    ds_write_b64 v75, v[58:59]
K2_S3_R:
    s_mov_b64 exec, -1
    s_cmp_eq_u32 s3, 0
    s_cbranch_scc0 FK_POLLWP
    s_mov_b64 exec, 2
    s_mov_b32 s64, 262144
FK_POLLP:
    s_add_u32 s24, s14, 0xf00000
    s_addc_u32 s25, s15, 0
    s_mov_b32 s26, 0x6000
    s_mov_b32 s27, 0x20000
    s_waitcnt vmcnt(0)
    v_sub_u32 v11, v11, v122
    v_cmp_eq_u32 vcc, 2, v11
    s_cbranch_vccnz FK_POLLXP
    s_sub_u32 s64, s64, 1
    s_cbranch_scc1 FK_POLLXP
    s_and_b32 s65, s64, 15
    s_cbranch_scc0 FK_POLLMP
FK_POLLBP:
    s_sleep 2
    buffer_load_dword v11, v123, s[24:27], 0 offen sc0 sc1
    s_branch FK_POLLP
FK_POLLXP:
    s_mov_b64 exec, 1
    ds_write_b32 v92, v4 offset:280
    s_branch FK_POLLDP
FK_POLLWP:
    s_mov_b32 s65, 4194304
FK_LWPP:
    ds_read_b32 v11, v92 offset:280
    s_sub_u32 s65, s65, 1
    s_cbranch_scc1 FK_LWXPP
    s_waitcnt lgkmcnt(0)
    v_readfirstlane_b32 s64, v11
    s_cmp_lt_u32 s64, 1
    s_cbranch_scc1 FK_LWPP
FK_LWXPP:
FK_POLLDP:
    s_mov_b64 exec, -1
    s_waitcnt lgkmcnt(0)
    s_branch K2_JOIN
K2_LOADER:
    v_and_b32 v3, 255, v0
    s_cmp_ge_u32 s80, 2
    s_cbranch_scc1 FK_ARRIVE
    s_waitcnt vmcnt(16)
    s_setprio 2
    ds_read_b64_tr_b16 v[60:61], v114 offset:0
    ds_read_b64_tr_b16 v[62:63], v114 offset:512
    ds_read_b64_tr_b16 v[64:65], v115 offset:0
    ds_read_b64_tr_b16 v[66:67], v115 offset:512
    ds_read_b64_tr_b16 v[68:69], v116 offset:0
    ds_read_b64_tr_b16 v[70:71], v116 offset:512
    ds_read_b64_tr_b16 v[72:73], v117 offset:0
    ds_read_b64_tr_b16 v[74:75], v117 offset:512
    ds_read_b128 v[168:171], v112 offset:0
    ds_read_b128 v[172:175], v112 offset:2048
    ds_read_b128 v[176:179], v112 offset:4096
    s_waitcnt lgkmcnt(0)
    ds_read_b64_tr_b16 v[76:77], v114 offset:4096
    ds_read_b64_tr_b16 v[78:79], v114 offset:4608
    ds_read_b64_tr_b16 v[80:81], v115 offset:4096
    ds_read_b64_tr_b16 v[82:83], v115 offset:4608
    ds_read_b64_tr_b16 v[84:85], v116 offset:4096
    ds_read_b64_tr_b16 v[86:87], v116 offset:4608
    ds_read_b64_tr_b16 v[88:89], v117 offset:4096
    ds_read_b64_tr_b16 v[90:91], v117 offset:4608
    ds_read_b128 v[180:183], v113 offset:0
    ds_read_b128 v[184:187], v113 offset:2048
    ds_read_b128 v[188:191], v113 offset:4096
    v_mfma_f32_16x16x32_bf16 v[192:195], v[60:63], v[168:171], 0
    v_mfma_f32_16x16x32_bf16 v[196:199], v[60:63], v[172:175], 0
    v_mfma_f32_16x16x32_bf16 v[200:203], v[60:63], v[176:179], 0
    v_mfma_f32_16x16x32_bf16 v[204:207], v[68:71], v[168:171], 0
    v_mfma_f32_16x16x32_bf16 v[208:211], v[68:71], v[172:175], 0
    v_mfma_f32_16x16x32_bf16 v[212:215], v[68:71], v[176:179], 0
    v_mfma_f32_16x16x32_bf16 v[216:219], v[64:67], v[168:171], 0
    v_mfma_f32_16x16x32_bf16 v[220:223], v[64:67], v[172:175], 0
    v_mfma_f32_16x16x32_bf16 v[224:227], v[64:67], v[176:179], 0
    v_mfma_f32_16x16x32_bf16 v[228:231], v[72:75], v[168:171], 0
    v_mfma_f32_16x16x32_bf16 v[232:235], v[72:75], v[172:175], 0
    v_mfma_f32_16x16x32_bf16 v[236:239], v[72:75], v[176:179], 0
    s_waitcnt lgkmcnt(0)
    ds_read_b64_tr_b16 v[60:61], v114 offset:32768
    ds_read_b64_tr_b16 v[62:63], v114 offset:33280
    ds_read_b64_tr_b16 v[64:65], v115 offset:32768
    ds_read_b64_tr_b16 v[66:67], v115 offset:33280
    ds_read_b64_tr_b16 v[68:69], v116 offset:32768
    ds_read_b64_tr_b16 v[70:71], v116 offset:33280
    ds_read_b64_tr_b16 v[72:73], v117 offset:32768
    ds_read_b64_tr_b16 v[74:75], v117 offset:33280
    ds_read_b128 v[168:171], v112 offset:6144
    ds_read_b128 v[172:175], v112 offset:8192
    ds_read_b128 v[176:179], v112 offset:10240
    v_mfma_f32_16x16x32_bf16 v[192:195], v[76:79], v[180:183], v[192:195]
    v_mfma_f32_16x16x32_bf16 v[196:199], v[76:79], v[184:187], v[196:199]
    v_mfma_f32_16x16x32_bf16 v[200:203], v[76:79], v[188:191], v[200:203]
    v_mfma_f32_16x16x32_bf16 v[204:207], v[84:87], v[180:183], v[204:207]
    v_mfma_f32_16x16x32_bf16 v[208:211], v[84:87], v[184:187], v[208:211]
    v_mfma_f32_16x16x32_bf16 v[212:215], v[84:87], v[188:191], v[212:215]
    v_mfma_f32_16x16x32_bf16 v[216:219], v[80:83], v[180:183], v[216:219]
    v_mfma_f32_16x16x32_bf16 v[220:223], v[80:83], v[184:187], v[220:223]
    v_mfma_f32_16x16x32_bf16 v[224:227], v[80:83], v[188:191], v[224:227]
    v_mfma_f32_16x16x32_bf16 v[228:231], v[88:91], v[180:183], v[228:231]
    v_mfma_f32_16x16x32_bf16 v[232:235], v[88:91], v[184:187], v[232:235]
    v_mfma_f32_16x16x32_bf16 v[236:239], v[88:91], v[188:191], v[236:239]
    s_waitcnt lgkmcnt(0)
    ds_read_b64_tr_b16 v[76:77], v114 offset:36864
    ds_read_b64_tr_b16 v[78:79], v114 offset:37376
    ds_read_b64_tr_b16 v[80:81], v115 offset:36864
    ds_read_b64_tr_b16 v[82:83], v115 offset:37376
    ds_read_b64_tr_b16 v[84:85], v116 offset:36864
    ds_read_b64_tr_b16 v[86:87], v116 offset:37376
    ds_read_b64_tr_b16 v[88:89], v117 offset:36864
    ds_read_b64_tr_b16 v[90:91], v117 offset:37376
    ds_read_b128 v[180:183], v113 offset:6144
    ds_read_b128 v[184:187], v113 offset:8192
    ds_read_b128 v[188:191], v113 offset:10240
    v_mfma_f32_16x16x32_bf16 v[192:195], v[60:63], v[168:171], v[192:195]
    v_mfma_f32_16x16x32_bf16 v[196:199], v[60:63], v[172:175], v[196:199]
    v_mfma_f32_16x16x32_bf16 v[200:203], v[60:63], v[176:179], v[200:203]
    v_mfma_f32_16x16x32_bf16 v[204:207], v[68:71], v[168:171], v[204:207]
    v_mfma_f32_16x16x32_bf16 v[208:211], v[68:71], v[172:175], v[208:211]
    v_mfma_f32_16x16x32_bf16 v[212:215], v[68:71], v[176:179], v[212:215]
    v_mfma_f32_16x16x32_bf16 v[216:219], v[64:67], v[168:171], v[216:219]
    v_mfma_f32_16x16x32_bf16 v[220:223], v[64:67], v[172:175], v[220:223]
    v_mfma_f32_16x16x32_bf16 v[224:227], v[64:67], v[176:179], v[224:227]
    v_mfma_f32_16x16x32_bf16 v[228:231], v[72:75], v[168:171], v[228:231]
    v_mfma_f32_16x16x32_bf16 v[232:235], v[72:75], v[172:175], v[232:235]
    v_mfma_f32_16x16x32_bf16 v[236:239], v[72:75], v[176:179], v[236:239]
    s_waitcnt lgkmcnt(0)
    s_setprio 0
    s_waitcnt vmcnt(0)
FK_ARRIVE:
    s_mov_b64 exec, 1
    ds_add_u32 v92, v4 offset:272
    s_cmp_lg_u32 s3, 4
    s_cbranch_scc1 FK_ARR_DONE
    s_mov_b32 s65, 4194304
FK_LWA8:
    ds_read_b32 v11, v92 offset:272
    s_sub_u32 s65, s65, 1
    s_cbranch_scc1 FK_LWXA8
    s_waitcnt lgkmcnt(0)
    v_readfirstlane_b32 s64, v11
    s_cmp_lt_u32 s64, 8
    s_cbranch_scc1 FK_LWA8
FK_LWXA8:
    s_cmp_eq_u32 s80, 2
    s_cbranch_scc1 FK_SIGEV
    s_mov_b32 s16, s12
    s_mov_b32 s17, s13
    s_mov_b32 s18, 0x100
    s_mov_b32 s19, 0x20000
    s_mov_b64 exec, 1
    s_and_b32 s64, s2, 1
    s_lshl_b32 s64, s64, 7
    v_mov_b32 v7, s64
    v_mov_b32 v8, 1
    buffer_atomic_add v8, v7, s[16:19], 0 offen offset:32 sc0 sc1
    ds_write_b32 v92, v4 offset:284
    s_add_u32 s20, s14, 0xf00000
    s_addc_u32 s21, s15, 0
    s_mov_b32 s22, 0x6000
    s_mov_b32 s23, 0x20000
    s_waitcnt vmcnt(0)
    v_readfirstlane_b32 s64, v8
    s_cmp_eq_u32 s64, 95
    s_cbranch_scc0 FK_SIGA
    s_mov_b64 exec, 0xffffffff
    v_lshlrev_b32 v7, 8, v1
    v_add_u32 v7, 8192, v7
    buffer_atomic_add v4, v7, s[20:23], 0 offen sc1
FK_SIGA:
    s_mov_b64 exec, -1
FK_SIGB:
    s_mov_b64 exec, 1
    ds_write_b32 v92, v4 offset:284
FK_ARR_DONE:
    s_mov_b64 exec, -1
    s_cmp_ge_u32 s80, 2
    s_cbranch_scc1 FK_OWNX
FK_OWNX_BACK:
    s_mov_b64 exec, -1
    s_mov_b32 s65, 4194304
FK_LWSG:
    ds_read_b32 v11, v92 offset:284
    s_sub_u32 s65, s65, 1
    s_cbranch_scc1 FK_LWXSG
    s_waitcnt lgkmcnt(0)
    v_readfirstlane_b32 s64, v11
    s_cmp_lt_u32 s64, 1
    s_cbranch_scc1 FK_LWSG
FK_LWXSG:
    s_nop 0
    s_add_u32 m0, s66, 0
    s_mov_b32 s64, 65536
    buffer_load_dwordx4 v124, s[24:27], s64 offen offset:0 lds
    buffer_load_dwordx4 v125, s[24:27], s64 offen offset:1024 lds
    buffer_load_dwordx4 v126, s[24:27], s64 offen offset:2048 lds
    buffer_load_dwordx4 v127, s[24:27], s64 offen offset:3072 lds
    s_add_u32 m0, s66, 4096
    s_mov_b32 s64, 81920
    buffer_load_dwordx4 v124, s[24:27], s64 offen offset:0 lds
    buffer_load_dwordx4 v125, s[24:27], s64 offen offset:1024 lds
    buffer_load_dwordx4 v126, s[24:27], s64 offen offset:2048 lds
    buffer_load_dwordx4 v127, s[24:27], s64 offen offset:3072 lds
    s_add_u32 m0, s66, 32768
    s_mov_b32 s64, 98304
    buffer_load_dwordx4 v124, s[24:27], s64 offen offset:0 lds
    buffer_load_dwordx4 v125, s[24:27], s64 offen offset:1024 lds
    buffer_load_dwordx4 v126, s[24:27], s64 offen offset:2048 lds
    buffer_load_dwordx4 v127, s[24:27], s64 offen offset:3072 lds
    s_add_u32 m0, s66, 36864
    s_mov_b32 s64, 114688
    buffer_load_dwordx4 v124, s[24:27], s64 offen offset:0 lds
    buffer_load_dwordx4 v125, s[24:27], s64 offen offset:1024 lds
    buffer_load_dwordx4 v126, s[24:27], s64 offen offset:2048 lds
    buffer_load_dwordx4 v127, s[24:27], s64 offen offset:3072 lds
    v_and_b32 v8, 15, v1
    v_cmp_gt_u32 s[68:69], 8, v8
    v_mov_b32 v30, 0xbfb8aa3b
    v_mov_b32 v31, 0xbfb8aa3b
    s_waitcnt vmcnt(12)
    s_setprio 2
    ds_read_b64_tr_b16 v[60:61], v114 offset:0
    ds_read_b64_tr_b16 v[62:63], v114 offset:512
    ds_read_b64_tr_b16 v[64:65], v115 offset:0
    ds_read_b64_tr_b16 v[66:67], v115 offset:512
    ds_read_b64_tr_b16 v[68:69], v116 offset:0
    ds_read_b64_tr_b16 v[70:71], v116 offset:512
    ds_read_b64_tr_b16 v[72:73], v117 offset:0
    ds_read_b64_tr_b16 v[74:75], v117 offset:512
    ds_read_b128 v[168:171], v112 offset:12288
    ds_read_b128 v[172:175], v112 offset:14336
    ds_read_b128 v[176:179], v112 offset:16384
    v_mfma_f32_16x16x32_bf16 v[192:195], v[76:79], v[180:183], v[192:195]
    v_mfma_f32_16x16x32_bf16 v[196:199], v[76:79], v[184:187], v[196:199]
    v_mfma_f32_16x16x32_bf16 v[200:203], v[76:79], v[188:191], v[200:203]
    v_mfma_f32_16x16x32_bf16 v[204:207], v[84:87], v[180:183], v[204:207]
    v_mfma_f32_16x16x32_bf16 v[208:211], v[84:87], v[184:187], v[208:211]
    v_mfma_f32_16x16x32_bf16 v[212:215], v[84:87], v[188:191], v[212:215]
    v_mfma_f32_16x16x32_bf16 v[216:219], v[80:83], v[180:183], v[216:219]
    v_mfma_f32_16x16x32_bf16 v[220:223], v[80:83], v[184:187], v[220:223]
    v_mfma_f32_16x16x32_bf16 v[224:227], v[80:83], v[188:191], v[224:227]
    v_mfma_f32_16x16x32_bf16 v[228:231], v[88:91], v[180:183], v[228:231]
    v_mfma_f32_16x16x32_bf16 v[232:235], v[88:91], v[184:187], v[232:235]
    v_mfma_f32_16x16x32_bf16 v[236:239], v[88:91], v[188:191], v[236:239]
    s_waitcnt lgkmcnt(0)
    s_waitcnt vmcnt(8)
    ds_read_b64_tr_b16 v[76:77], v114 offset:4096
    ds_read_b64_tr_b16 v[78:79], v114 offset:4608
    ds_read_b64_tr_b16 v[80:81], v115 offset:4096
    ds_read_b64_tr_b16 v[82:83], v115 offset:4608
    ds_read_b64_tr_b16 v[84:85], v116 offset:4096
    ds_read_b64_tr_b16 v[86:87], v116 offset:4608
    ds_read_b64_tr_b16 v[88:89], v117 offset:4096
    ds_read_b64_tr_b16 v[90:91], v117 offset:4608
    ds_read_b128 v[180:183], v113 offset:12288
    ds_read_b128 v[184:187], v113 offset:14336
    ds_read_b128 v[188:191], v113 offset:16384
    v_mfma_f32_16x16x32_bf16 v[192:195], v[60:63], v[168:171], v[192:195]
    v_mfma_f32_16x16x32_bf16 v[196:199], v[60:63], v[172:175], v[196:199]
    v_mfma_f32_16x16x32_bf16 v[200:203], v[60:63], v[176:179], v[200:203]
    v_mfma_f32_16x16x32_bf16 v[204:207], v[68:71], v[168:171], v[204:207]
    v_mfma_f32_16x16x32_bf16 v[208:211], v[68:71], v[172:175], v[208:211]
    v_mfma_f32_16x16x32_bf16 v[212:215], v[68:71], v[176:179], v[212:215]
    v_mfma_f32_16x16x32_bf16 v[216:219], v[64:67], v[168:171], v[216:219]
    v_mfma_f32_16x16x32_bf16 v[220:223], v[64:67], v[172:175], v[220:223]
    v_mfma_f32_16x16x32_bf16 v[224:227], v[64:67], v[176:179], v[224:227]
    v_mfma_f32_16x16x32_bf16 v[228:231], v[72:75], v[168:171], v[228:231]
    v_mfma_f32_16x16x32_bf16 v[232:235], v[72:75], v[172:175], v[232:235]
    v_mfma_f32_16x16x32_bf16 v[236:239], v[72:75], v[176:179], v[236:239]
    s_waitcnt lgkmcnt(0)
    s_waitcnt vmcnt(4)
    ds_read_b64_tr_b16 v[60:61], v114 offset:32768
    ds_read_b64_tr_b16 v[62:63], v114 offset:33280
    ds_read_b64_tr_b16 v[64:65], v115 offset:32768
    ds_read_b64_tr_b16 v[66:67], v115 offset:33280
    ds_read_b64_tr_b16 v[68:69], v116 offset:32768
    ds_read_b64_tr_b16 v[70:71], v116 offset:33280
    ds_read_b64_tr_b16 v[72:73], v117 offset:32768
    ds_read_b64_tr_b16 v[74:75], v117 offset:33280
    ds_read_b128 v[168:171], v112 offset:18432
    ds_read_b128 v[172:175], v112 offset:20480
    ds_read_b128 v[176:179], v112 offset:22528
    v_mfma_f32_16x16x32_bf16 v[192:195], v[76:79], v[180:183], v[192:195]
    v_mfma_f32_16x16x32_bf16 v[196:199], v[76:79], v[184:187], v[196:199]
    v_mfma_f32_16x16x32_bf16 v[200:203], v[76:79], v[188:191], v[200:203]
    v_mfma_f32_16x16x32_bf16 v[204:207], v[84:87], v[180:183], v[204:207]
    v_mfma_f32_16x16x32_bf16 v[208:211], v[84:87], v[184:187], v[208:211]
    v_mfma_f32_16x16x32_bf16 v[212:215], v[84:87], v[188:191], v[212:215]
    v_mfma_f32_16x16x32_bf16 v[216:219], v[80:83], v[180:183], v[216:219]
    v_mfma_f32_16x16x32_bf16 v[220:223], v[80:83], v[184:187], v[220:223]
    v_mfma_f32_16x16x32_bf16 v[224:227], v[80:83], v[188:191], v[224:227]
    v_mfma_f32_16x16x32_bf16 v[228:231], v[88:91], v[180:183], v[228:231]
    v_mfma_f32_16x16x32_bf16 v[232:235], v[88:91], v[184:187], v[232:235]
    v_mfma_f32_16x16x32_bf16 v[236:239], v[88:91], v[188:191], v[236:239]
    s_waitcnt lgkmcnt(0)
    s_waitcnt vmcnt(0)
    ds_read_b64_tr_b16 v[76:77], v114 offset:36864
    ds_read_b64_tr_b16 v[78:79], v114 offset:37376
    ds_read_b64_tr_b16 v[80:81], v115 offset:36864
    ds_read_b64_tr_b16 v[82:83], v115 offset:37376
    ds_read_b64_tr_b16 v[84:85], v116 offset:36864
    ds_read_b64_tr_b16 v[86:87], v116 offset:37376
    ds_read_b64_tr_b16 v[88:89], v117 offset:36864
    ds_read_b64_tr_b16 v[90:91], v117 offset:37376
    ds_read_b128 v[180:183], v113 offset:18432
    ds_read_b128 v[184:187], v113 offset:20480
    ds_read_b128 v[188:191], v113 offset:22528
    v_mfma_f32_16x16x32_bf16 v[192:195], v[60:63], v[168:171], v[192:195]
    v_mfma_f32_16x16x32_bf16 v[196:199], v[60:63], v[172:175], v[196:199]
    v_mfma_f32_16x16x32_bf16 v[200:203], v[60:63], v[176:179], v[200:203]
    v_mfma_f32_16x16x32_bf16 v[204:207], v[68:71], v[168:171], v[204:207]
    v_mfma_f32_16x16x32_bf16 v[208:211], v[68:71], v[172:175], v[208:211]
    v_mfma_f32_16x16x32_bf16 v[212:215], v[68:71], v[176:179], v[212:215]
    v_mfma_f32_16x16x32_bf16 v[216:219], v[64:67], v[168:171], v[216:219]
    v_mfma_f32_16x16x32_bf16 v[220:223], v[64:67], v[172:175], v[220:223]
    v_mfma_f32_16x16x32_bf16 v[224:227], v[64:67], v[176:179], v[224:227]
    v_mfma_f32_16x16x32_bf16 v[228:231], v[72:75], v[168:171], v[228:231]
    v_mfma_f32_16x16x32_bf16 v[232:235], v[72:75], v[172:175], v[232:235]
    v_mfma_f32_16x16x32_bf16 v[236:239], v[72:75], v[176:179], v[236:239]
    s_waitcnt lgkmcnt(0)
    v_mfma_f32_16x16x32_bf16 v[192:195], v[76:79], v[180:183], v[192:195]
    v_mfma_f32_16x16x32_bf16 v[196:199], v[76:79], v[184:187], v[196:199]
    v_mfma_f32_16x16x32_bf16 v[200:203], v[76:79], v[188:191], v[200:203]
    v_mfma_f32_16x16x32_bf16 v[204:207], v[84:87], v[180:183], v[204:207]
    v_mfma_f32_16x16x32_bf16 v[208:211], v[84:87], v[184:187], v[208:211]
    v_mfma_f32_16x16x32_bf16 v[212:215], v[84:87], v[188:191], v[212:215]
    v_mfma_f32_16x16x32_bf16 v[216:219], v[80:83], v[180:183], v[216:219]
    v_mfma_f32_16x16x32_bf16 v[220:223], v[80:83], v[184:187], v[220:223]
    v_mfma_f32_16x16x32_bf16 v[224:227], v[80:83], v[188:191], v[224:227]
    v_mfma_f32_16x16x32_bf16 v[228:231], v[88:91], v[180:183], v[228:231]
    v_mfma_f32_16x16x32_bf16 v[232:235], v[88:91], v[184:187], v[232:235]
    v_mfma_f32_16x16x32_bf16 v[236:239], v[88:91], v[188:191], v[236:239]
    s_nop 1
    v_pk_mul_f32 v[192:193], v[192:193], v[30:31]
    v_pk_mul_f32 v[204:205], v[204:205], v[30:31]
    v_pk_mul_f32 v[194:195], v[194:195], v[30:31]
    v_pk_mul_f32 v[206:207], v[206:207], v[30:31]
    v_cvt_pk_bf16_f32 v192, v192, v204
    v_cvt_pk_bf16_f32 v193, v193, v205
    v_cvt_pk_bf16_f32 v194, v194, v206
    v_cvt_pk_bf16_f32 v195, v195, v207
    ds_write_b128 v118, v[192:195] offset:0
    v_pk_mul_f32 v[216:217], v[216:217], v[30:31]
    v_pk_mul_f32 v[228:229], v[228:229], v[30:31]
    v_pk_mul_f32 v[218:219], v[218:219], v[30:31]
    v_pk_mul_f32 v[230:231], v[230:231], v[30:31]
    v_cvt_pk_bf16_f32 v216, v216, v228
    v_cvt_pk_bf16_f32 v217, v217, v229
    v_cvt_pk_bf16_f32 v218, v218, v230
    v_cvt_pk_bf16_f32 v219, v219, v231
    ds_write_b128 v119, v[216:219] offset:0
    v_pk_mul_f32 v[196:197], v[196:197], v[30:31]
    v_pk_mul_f32 v[208:209], v[208:209], v[30:31]
    v_pk_mul_f32 v[198:199], v[198:199], v[30:31]
    v_pk_mul_f32 v[210:211], v[210:211], v[30:31]
    v_cvt_pk_bf16_f32 v196, v196, v208
    v_cvt_pk_bf16_f32 v197, v197, v209
    v_cvt_pk_bf16_f32 v198, v198, v210
    v_cvt_pk_bf16_f32 v199, v199, v211
    ds_write_b128 v118, v[196:199] offset:8192
    v_pk_mul_f32 v[220:221], v[220:221], v[30:31]
    v_pk_mul_f32 v[232:233], v[232:233], v[30:31]
    v_pk_mul_f32 v[222:223], v[222:223], v[30:31]
    v_pk_mul_f32 v[234:235], v[234:235], v[30:31]
    v_cvt_pk_bf16_f32 v220, v220, v232
    v_cvt_pk_bf16_f32 v221, v221, v233
    v_cvt_pk_bf16_f32 v222, v222, v234
    v_cvt_pk_bf16_f32 v223, v223, v235
    ds_write_b128 v119, v[220:223] offset:8192
    s_mov_b64 exec, s[68:69]
    v_pk_mul_f32 v[200:201], v[200:201], v[30:31]
    v_pk_mul_f32 v[212:213], v[212:213], v[30:31]
    v_pk_mul_f32 v[202:203], v[202:203], v[30:31]
    v_pk_mul_f32 v[214:215], v[214:215], v[30:31]
    v_cvt_pk_bf16_f32 v200, v200, v212
    v_cvt_pk_bf16_f32 v201, v201, v213
    v_cvt_pk_bf16_f32 v202, v202, v214
    v_cvt_pk_bf16_f32 v203, v203, v215
    ds_write_b128 v118, v[200:203] offset:16384
    v_pk_mul_f32 v[224:225], v[224:225], v[30:31]
    v_pk_mul_f32 v[236:237], v[236:237], v[30:31]
    v_pk_mul_f32 v[226:227], v[226:227], v[30:31]
    v_pk_mul_f32 v[238:239], v[238:239], v[30:31]
    v_cvt_pk_bf16_f32 v224, v224, v236
    v_cvt_pk_bf16_f32 v225, v225, v237
    v_cvt_pk_bf16_f32 v226, v226, v238
    v_cvt_pk_bf16_f32 v227, v227, v239
    ds_write_b128 v119, v[224:227] offset:16384
    s_mov_b64 exec, -1
    s_waitcnt lgkmcnt(0)
    s_setprio 0
K2_JOIN:
    s_barrier
    v_lshlrev_b32 v3, 2, v1
    v_add_u32 v3, 152352, v3
    ds_read_b32 v3, v3
    v_bfe_u32 v4, v1, 2, 1
    v_lshrrev_b32 v5, 5, v1
    v_mov_b32 v21, v141
    v_mov_b32 v23, v143
    v_mov_b32 v25, v145
    v_mov_b32 v27, v147
    s_mov_b32 m0, s55
    s_waitcnt lgkmcnt(0)
    v_readlane_b32 s64, v3, 0
    v_readlane_b32 s66, v3, 1
    s_cmp_eq_u32 s53, 0
    s_cselect_b32 s54, s64, s66
    s_cselect_b32 s64, 0, s64
    s_lshl_b32 s64, s64, 3
    s_lshl_b32 s66, s54, 2
    v_mov_b32 v6, s64
    v_mad_u32_u24 v5, v5, s66, v6
    v_lshl_add_u32 v159, v5, 6, v159
    ds_read_b32 v140, v159 offset:0
    ds_read_b32 v142, v159 offset:64
    ds_read_b32 v144, v159 offset:128
    ds_read_b32 v146, v159 offset:192
    ds_read_b32 v20, v159 offset:256
    ds_read_b32 v22, v159 offset:320
    ds_read_b32 v24, v159 offset:384
    ds_read_b32 v26, v159 offset:448
    v_mad_u32_u24 v4, v4, s66, v6
    v_lshl_add_u32 v158, v4, 6, v158
    v_lshl_add_u32 v160, v4, 2, v160
    v_lshlrev_b32 v161, 2, v5
    v_add_u32 v161, 150016, v161
    s_waitcnt lgkmcnt(4)
    buffer_load_dwordx4 v[140:141], s[36:39], 0 idxen offen offset:0 lds
    buffer_load_dwordx4 v[142:143], s[40:43], 0 idxen offen offset:1024 lds
    buffer_load_dwordx4 v[144:145], s[44:47], 0 idxen offen offset:2048 lds
    buffer_load_dwordx4 v[146:147], s[48:51], 0 idxen offen offset:3072 lds
    s_lshl_b32 s64, s52, 10
    s_add_u32 s64, s64, 393216
    v_lshlrev_b32 v4, 3, v1
    buffer_load_dwordx2 v[124:125], v4, s[28:31], s64 offen
    buffer_load_dwordx2 v[128:129], v4, s[28:31], s64 offen offset:512
    ds_read_b32 v140, v159 offset:512
    ds_read_b32 v142, v159 offset:576
    ds_read_b32 v144, v159 offset:640
    ds_read_b32 v146, v159 offset:704
    ds_read_b32 v162, v160
    ds_read_b96 v[116:118], v158
    ds_read_b96 v[120:122], v158 offset:256
    s_mov_b32 m0, s56
    v_readlane_b32 s60, v3, 2
    v_readlane_b32 s61, v3, 3
    v_readlane_b32 s62, v3, 4
    v_readlane_b32 s82, v3, 5
    s_add_u32 s67, s63, 131072
    s_add_u32 s68, s67, 8192
    s_sub_u32 s69, s54, 8
    s_cmp_ge_u32 s54, 10
    s_cselect_b32 s69, s69, 0
    s_waitcnt lgkmcnt(7)
    s_barrier
    buffer_load_dwordx4 v[192:195], v2, s[28:31], s67 offen
    buffer_load_dwordx4 v[196:199], v2, s[28:31], s68 offen
    buffer_load_dwordx4 v[20:21], s[36:39], 0 idxen offen offset:0 lds
    buffer_load_dwordx4 v[22:23], s[40:43], 0 idxen offen offset:1024 lds
    buffer_load_dwordx4 v[24:25], s[44:47], 0 idxen offen offset:2048 lds
    buffer_load_dwordx4 v[26:27], s[48:51], 0 idxen offen offset:3072 lds
    v_mov_b32 v168, 0
    v_mov_b32 v169, 0
    v_mov_b32 v170, 0
    v_mov_b32 v171, 0
    v_mov_b32 v172, 0
    v_mov_b32 v173, 0
    v_mov_b32 v174, 0
    v_mov_b32 v175, 0
    v_mov_b32 v176, 0
    v_mov_b32 v177, 0
    v_mov_b32 v178, 0
    v_mov_b32 v179, 0
    v_mov_b32 v180, 0
    v_mov_b32 v181, 0
    v_mov_b32 v182, 0
    v_mov_b32 v183, 0
    v_mov_b32 v184, 0
    v_mov_b32 v185, 0
    v_mov_b32 v186, 0
    v_mov_b32 v187, 0
    v_mov_b32 v188, 0
    v_mov_b32 v189, 0
    v_mov_b32 v190, 0
    v_mov_b32 v191, 0
    v_mov_b32 v200, 0
    v_mov_b32 v201, 0
    v_mov_b32 v202, 0
    v_mov_b32 v203, 0
    v_mov_b32 v204, 0
    v_mov_b32 v205, 0
    v_mov_b32 v206, 0
    v_mov_b32 v207, 0
    v_mov_b32 v224, 0
    v_mov_b32 v225, 0
    v_mov_b32 v226, 0
    v_mov_b32 v227, 0
    v_mov_b32 v228, 0
    v_mov_b32 v229, 0
    v_mov_b32 v230, 0
    v_mov_b32 v231, 0
    v_and_b32 v4, 15, v1
    v_lshrrev_b32 v5, 4, v1
    v_bfe_u32 v232, v1, 1, 3
    v_xor_b32 v5, v5, v232
    v_lshlrev_b32 v4, 7, v4
    v_add_u32 v4, 65536, v4
    v_lshl_add_u32 v232, v5, 4, v4
    v_xor_b32 v233, 64, v232
    v_lshrrev_b32 v4, 4, v1
    v_and_b32 v5, 15, v1
    s_lshl_b32 s64, s3, 6
    v_lshl_add_u32 v6, v5, 2, s64
    v_mov_b32 v82, s60
    v_mov_b32 v7, s61
    v_cmp_eq_u32 vcc, 1, v4
    v_mov_b32 v8, s62
    v_cmp_eq_u32 s[64:65], 2, v4
    v_cndmask_b32_e64 v82, v82, v7, vcc
    v_add_u32 v83, 41, v4
    v_cndmask_b32 v82, v82, v8, s[64:65]
    v_and_b32 v7, 15, v82
    v_lshlrev_b32 v7, 4, v7
    v_xor_b32 v7, v7, v6
    v_lshl_add_u32 v82, v82, 9, v7
    v_add_u32 v82, 110592, v82
    v_and_b32 v7, 15, v83
    v_lshlrev_b32 v7, 4, v7
    v_xor_b32 v7, v7, v6
    v_lshl_add_u32 v83, v83, 9, v7
    v_add_u32 v83, 110592, v83
    s_mul_i32 s64, s2, 625
    s_lshr_b32 s64, s64, 4
    s_add_u32 s70, s2, 1
    s_mul_i32 s70, s70, 625
    s_lshr_b32 s70, s70, 4
    s_sub_u32 s70, s70, s64
    s_lshl_b32 s64, s64, 9
    v_lshl_add_u32 v0, v4, 11, v6
    v_add_u32 v0, s64, v0
    v_xor_b32 v4, v4, v5
    v_lshlrev_b32 v5, 9, v5
    v_lshl_add_u32 v3, v4, 4, v5
    v_add_u32 v3, 110592, v3
    v_mov_b32 v64, 0
    v_mov_b32 v56, 1.0
    v_mov_b32 v68, 0
    v_mov_b32 v72, 0
    v_mov_b32 v154, 0
    v_mov_b32 v80, 0
    v_mov_b32 v84, 131200
    v_mov_b32 v65, 0
    v_mov_b32 v57, 1.0
    v_mov_b32 v69, 0
    v_mov_b32 v73, 0
    v_mov_b32 v155, 0
    v_mov_b32 v81, 0
    v_mov_b32 v85, 131200
    v_mov_b32 v66, 0
    v_mov_b32 v58, 1.0
    v_mov_b32 v70, 0
    v_mov_b32 v74, 0
    v_mov_b32 v156, 0
    v_mov_b32 v86, 131200
    v_mov_b32 v67, 0
    v_mov_b32 v59, 1.0
    v_mov_b32 v71, 0
    v_mov_b32 v75, 0
    v_mov_b32 v157, 0
    v_mov_b32 v87, 131200
    v_xor_b32 v88, 131200, v167
    v_mov_b32 v89, v88
    v_mov_b32 v90, v88
    v_mov_b32 v91, v88
    s_waitcnt lgkmcnt(1)
    v_xor_b32 v163, v162, v165
    v_xor_b32 v164, v162, v166
    v_and_b32 v119, v153, v118
    v_and_b32 v118, v152, v118
    ds_read_b64_tr_b16 v[126:127], v163
    ds_read_b64_tr_b16 v[130:131], v164
    ds_read_b32 v162, v160 offset:16
    s_mov_b32 s65, 2
    s_mov_b32 m0, s55
    s_waitcnt vmcnt(8)
    ds_read_b128 v[92:95], v148
    ds_read_b128 v[96:99], v149
    ds_read_b128 v[100:103], v150
    ds_read_b128 v[104:107], v151
    s_waitcnt lgkmcnt(2)
    v_mfma_f32_32x32x16_bf16 v[4:19], v[92:95], v[132:135], 0
    v_mfma_f32_32x32x16_bf16 v[4:19], v[96:99], v[136:139], v[4:19]
    s_waitcnt vmcnt(6)
    v_mfma_f32_32x32x16_bf16 v[4:19], v[116:119], v[124:127], v[4:19]
    v_xor_b32 v163, v162, v165
    v_xor_b32 v164, v162, v166
    s_cmp_lt_u32 s54, 3
    s_waitcnt lgkmcnt(0)
    s_cbranch_scc1 K2_FEW
    s_cmp_lg_u32 s69, 0
    s_cselect_b32 s65, 3, 2
    s_cbranch_scc1 K2_FEW_BACK
    buffer_load_dwordx4 v[140:141], s[36:39], 0 idxen offen offset:0 lds
    buffer_load_dwordx4 v[142:143], s[40:43], 0 idxen offen offset:1024 lds
    buffer_load_dwordx4 v[144:145], s[44:47], 0 idxen offen offset:2048 lds
    buffer_load_dwordx4 v[146:147], s[48:51], 0 idxen offen offset:3072 lds
K2_FEW_BACK:
    s_nop 3
    s_cmp_eq_u32 s54, 0
    s_cbranch_scc1 K2_TAIL
    s_cmp_eq_u32 s53, 0
    s_cbranch_scc0 K2_R1
    s_setprio 2
    s_cmp_eq_u32 s69, 0
    s_cbranch_scc1 K2_LOOP0
.p2align 3
K2_LOOPA0:
    v_mfma_f32_16x16x32_bf16 v[180:183], v[224:227], v[204:207], v[180:183]
    v_rcp_f32 v56, v56
    v_rcp_f32 v58, v58
    v_mfma_f32_32x32x16_bf16 v[20:35], v[100:103], v[132:135], 0
    v_exp_f32 v36, v4
    v_exp_f32 v37, v5
    v_exp_f32 v38, v6
    v_exp_f32 v39, v7
    v_mfma_f32_16x16x32_bf16 v[184:187], v[228:231], v[200:203], v[184:187]
    v_exp_f32 v40, v8
    v_exp_f32 v41, v9
    v_mfma_f32_32x32x16_bf16 v[20:35], v[104:107], v[136:139], v[20:35]
    v_exp_f32 v42, v10
    v_exp_f32 v43, v11
    v_exp_f32 v44, v12
    v_exp_f32 v45, v13
    v_mfma_f32_16x16x32_bf16 v[188:191], v[228:231], v[204:207], v[188:191]
    v_exp_f32 v46, v14
    v_exp_f32 v47, v15
    v_mfma_f32_32x32x16_bf16 v[20:35], v[116:119], v[128:131], v[20:35]
    v_exp_f32 v48, v16
    v_exp_f32 v49, v17
    v_exp_f32 v50, v18
    v_exp_f32 v51, v19
    s_setprio 0
    s_cmp_eq_u32 s65, 3
    s_cbranch_scc1 K2_F0
    s_waitcnt vmcnt(4)
K2_FB0:
    ds_read_b128 v[92:95], v148 offset:4096
    ds_read_b128 v[96:99], v149 offset:4096
    ds_read_b128 v[108:111], v150 offset:4096
    ds_read_b128 v[112:115], v151 offset:4096
    ds_read_b64_tr_b16 v[126:127], v163
    ds_read_b32 v140, v159 offset:768
    ds_read_b32 v142, v159 offset:832
    ds_read_b32 v144, v159 offset:896
    ds_read_b32 v146, v159 offset:960
    ds_read_b128 v[208:211], v232 offset:0
    ds_read_b128 v[212:215], v232 offset:2048
    ds_read_b128 v[216:219], v232 offset:4096
    s_mov_b32 m0, s56
    v_add_f32 v52, 1.0, v36
    v_add_f32 v53, 1.0, v41
    v_add_f32 v54, 1.0, v46
    v_add_f32 v55, 1.0, v51
    v_fmac_f32 v4, v4, v37
    v_fmac_f32 v9, v9, v42
    v_fmac_f32 v14, v14, v47
    v_fmac_f32 v19, v19, v48
    v_fmac_f32 v4, v5, v52
    v_fmac_f32 v9, v10, v53
    v_fmac_f32 v14, v15, v54
    v_fmac_f32 v19, v16, v55
    v_fmac_f32 v52, v52, v37
    v_fmac_f32 v53, v53, v42
    v_fmac_f32 v54, v54, v47
    v_fmac_f32 v55, v55, v48
    v_fmac_f32 v4, v4, v38
    v_fmac_f32 v9, v9, v43
    v_fmac_f32 v14, v14, v44
    v_fmac_f32 v19, v19, v49
    v_fmac_f32 v4, v6, v52
    v_fmac_f32 v9, v11, v53
    v_fmac_f32 v14, v12, v54
    s_setprio 2
    v_fmac_f32 v19, v17, v55
    v_fmac_f32 v52, v52, v38
    v_fmac_f32 v53, v53, v43
    v_fmac_f32 v54, v54, v44
    s_waitcnt lgkmcnt(0)
    v_mul_f32 v72, v64, v56
    v_fmac_f32 v55, v55, v49
    v_fmac_f32 v4, v4, v39
    v_fmac_f32 v9, v9, v40
    v_fmac_f32 v72, v75, v154
    v_mul_f32 v73, v65, v56
    v_mul_f32 v74, v66, v58
    v_mul_f32 v75, v67, v58
    v_fmac_f32 v14, v14, v45
    v_fmac_f32 v19, v19, v50
    v_fma_f32 v60, v7, v52, v4
    v_fmac_f32 v73, v72, v155
    v_fma_f32 v61, v8, v53, v9
    v_fma_f32 v62, v13, v54, v14
    v_fma_f32 v63, v18, v55, v19
    v_fmac_f32 v74, v73, v156
    v_fmac_f32 v52, v52, v39
    v_fmac_f32 v53, v53, v40
    v_fmac_f32 v54, v54, v45
    v_fmac_f32 v75, v74, v157
    v_fmac_f32 v55, v55, v50
    v_mul_f32 v60, v60, v53
    v_mul_f32 v61, v61, v52
    v_mul_f32 v62, v62, v55
    v_mul_f32 v63, v63, v54
    v_mul_f32 v52, v52, v53
    v_mul_f32 v54, v54, v55
    v_add_f32 v80, v80, v52
    v_add_f32 v81, v81, v54
    v_and_b32 v123, v153, v122
    v_and_b32 v122, v152, v122
    v_mfma_f32_16x16x32_bf16 v[168:171], v[208:211], v[192:195], v[168:171]
    v_rcp_f32 v52, v52
    v_rcp_f32 v54, v54
    v_mfma_f32_32x32x16_bf16 v[4:19], v[92:95], v[132:135], 0
    v_exp_f32 v36, v20
    v_exp_f32 v37, v21
    v_exp_f32 v38, v22
    v_cvt_pk_bf16_f32 v76, v68, v72
    v_exp_f32 v39, v23
    v_mfma_f32_16x16x32_bf16 v[172:175], v[208:211], v[196:199], v[172:175]
    v_exp_f32 v40, v24
    v_cvt_pk_bf16_f32 v77, v69, v73
    v_exp_f32 v41, v25
    v_mfma_f32_32x32x16_bf16 v[4:19], v[96:99], v[136:139], v[4:19]
    v_exp_f32 v42, v26
    v_exp_f32 v43, v27
    v_cvt_pk_bf16_f32 v78, v70, v74
    v_exp_f32 v44, v28
    v_exp_f32 v45, v29
    v_cvt_pk_bf16_f32 v79, v71, v75
    v_mfma_f32_16x16x32_bf16 v[176:179], v[212:215], v[192:195], v[176:179]
    v_exp_f32 v46, v30
    v_exp_f32 v47, v31
    v_mfma_f32_32x32x16_bf16 v[4:19], v[120:123], v[124:127], v[4:19]
    v_exp_f32 v48, v32
    v_exp_f32 v49, v33
    v_exp_f32 v50, v34
    v_exp_f32 v51, v35
    s_setprio 0
    ds_write_b32 v88, v76
    ds_write_b32 v89, v77
    ds_write_b32 v90, v78
    ds_write_b32 v91, v79
    ds_read_b128 v[154:157], v161 offset:1024
    ds_read_b128 v[84:87], v161 offset:0
    ds_read_b32 v162, v160 offset:32
    ds_read_b64_tr_b16 v[130:131], v164
    ds_read_b96 v[116:118], v158 offset:512
    buffer_load_dwordx4 v[200:203], v2, s[28:31], s67 offen offset:1024
    buffer_load_dwordx4 v[204:207], v2, s[28:31], s68 offen offset:1024
    buffer_load_dwordx4 v[140:141], s[36:39], 0 idxen offen offset:0 lds
    buffer_load_dwordx4 v[142:143], s[40:43], 0 idxen offen offset:1024 lds
    buffer_load_dwordx4 v[144:145], s[44:47], 0 idxen offen offset:2048 lds
    buffer_load_dwordx4 v[146:147], s[48:51], 0 idxen offen offset:3072 lds
    s_sub_u32 s54, s54, 1
    v_add_f32 v56, 1.0, v36
    v_add_f32 v57, 1.0, v41
    v_add_f32 v58, 1.0, v46
    v_add_f32 v59, 1.0, v51
    v_fmac_f32 v20, v20, v37
    v_fmac_f32 v25, v25, v42
    v_fmac_f32 v30, v30, v47
    v_fmac_f32 v35, v35, v48
    v_fmac_f32 v20, v21, v56
    v_fmac_f32 v25, v26, v57
    v_fmac_f32 v30, v31, v58
    v_fmac_f32 v35, v32, v59
    v_fmac_f32 v56, v56, v37
    v_fmac_f32 v57, v57, v42
    v_fmac_f32 v58, v58, v47
    v_fmac_f32 v59, v59, v48
    v_fmac_f32 v20, v20, v38
    v_fmac_f32 v25, v25, v43
    v_fmac_f32 v30, v30, v44
    v_fmac_f32 v35, v35, v49
    v_fmac_f32 v20, v22, v56
    v_fmac_f32 v25, v27, v57
    v_fmac_f32 v30, v28, v58
    v_fmac_f32 v35, v33, v59
    v_fmac_f32 v56, v56, v38
    v_fmac_f32 v57, v57, v43
    v_fmac_f32 v58, v58, v44
    s_waitcnt lgkmcnt(0)
    s_setprio 2
    v_mul_f32 v68, v60, v52
    v_fmac_f32 v59, v59, v49
    v_fmac_f32 v20, v20, v39
    v_fmac_f32 v25, v25, v40
    v_fmac_f32 v68, v71, v154
    v_mul_f32 v69, v61, v52
    v_mul_f32 v70, v62, v54
    v_mul_f32 v71, v63, v54
    v_fmac_f32 v30, v30, v45
    v_fmac_f32 v35, v35, v50
    v_fma_f32 v64, v23, v56, v20
    v_fmac_f32 v69, v68, v155
    v_fma_f32 v65, v24, v57, v25
    v_fma_f32 v66, v29, v58, v30
    v_fma_f32 v67, v34, v59, v35
    v_fmac_f32 v70, v69, v156
    v_fmac_f32 v56, v56, v39
    v_fmac_f32 v57, v57, v40
    v_fmac_f32 v58, v58, v45
    v_fmac_f32 v71, v70, v157
    v_fmac_f32 v59, v59, v50
    v_mul_f32 v64, v64, v57
    v_mul_f32 v65, v65, v56
    v_mul_f32 v66, v66, v59
    v_mul_f32 v67, v67, v58
    v_mul_f32 v56, v56, v57
    v_mul_f32 v58, v58, v59
    v_add_f32 v80, v80, v56
    v_add_f32 v81, v81, v58
    v_xor_b32 v163, v162, v165
    v_xor_b32 v164, v162, v166
    v_add_u32 v232, 6144, v232
    v_xor_b32 v88, v84, v167
    v_xor_b32 v89, v85, v167
    v_xor_b32 v90, v86, v167
    v_xor_b32 v91, v87, v167
    v_mfma_f32_16x16x32_bf16 v[180:183], v[212:215], v[196:199], v[180:183]
    v_rcp_f32 v56, v56
    v_rcp_f32 v58, v58
    v_mfma_f32_32x32x16_bf16 v[20:35], v[108:111], v[132:135], 0
    v_exp_f32 v36, v4
    v_exp_f32 v37, v5
    v_exp_f32 v38, v6
    v_exp_f32 v39, v7
    v_mfma_f32_16x16x32_bf16 v[184:187], v[216:219], v[192:195], v[184:187]
    v_exp_f32 v40, v8
    v_exp_f32 v41, v9
    v_mfma_f32_32x32x16_bf16 v[20:35], v[112:115], v[136:139], v[20:35]
    v_exp_f32 v42, v10
    v_exp_f32 v43, v11
    v_exp_f32 v44, v12
    v_exp_f32 v45, v13
    v_mfma_f32_16x16x32_bf16 v[188:191], v[216:219], v[196:199], v[188:191]
    v_exp_f32 v46, v14
    v_exp_f32 v47, v15
    v_mfma_f32_32x32x16_bf16 v[20:35], v[120:123], v[128:131], v[20:35]
    v_exp_f32 v48, v16
    v_exp_f32 v49, v17
    v_exp_f32 v50, v18
    v_exp_f32 v51, v19
    s_setprio 0
    s_waitcnt vmcnt(4)
    ds_read_b128 v[92:95], v148 offset:0
    ds_read_b128 v[96:99], v149 offset:0
    ds_read_b128 v[100:103], v150 offset:0
    ds_read_b128 v[104:107], v151 offset:0
    ds_read_b64_tr_b16 v[126:127], v163
    ds_read_b32 v140, v159 offset:1024
    ds_read_b32 v142, v159 offset:1088
    ds_read_b32 v144, v159 offset:1152
    ds_read_b32 v146, v159 offset:1216
    ds_read_b128 v[220:223], v233 offset:0
    ds_read_b128 v[224:227], v233 offset:2048
    ds_read_b128 v[228:231], v233 offset:4096
    s_mov_b32 m0, s55
    v_add_f32 v52, 1.0, v36
    v_add_f32 v53, 1.0, v41
    v_add_f32 v54, 1.0, v46
    v_add_f32 v55, 1.0, v51
    v_fmac_f32 v4, v4, v37
    v_fmac_f32 v9, v9, v42
    v_fmac_f32 v14, v14, v47
    v_fmac_f32 v19, v19, v48
    v_fmac_f32 v4, v5, v52
    v_fmac_f32 v9, v10, v53
    v_fmac_f32 v14, v15, v54
    v_fmac_f32 v19, v16, v55
    v_fmac_f32 v52, v52, v37
    v_fmac_f32 v53, v53, v42
    v_fmac_f32 v54, v54, v47
    v_fmac_f32 v55, v55, v48
    v_fmac_f32 v4, v4, v38
    v_fmac_f32 v9, v9, v43
    v_fmac_f32 v14, v14, v44
    v_fmac_f32 v19, v19, v49
    v_fmac_f32 v4, v6, v52
    v_fmac_f32 v9, v11, v53
    v_fmac_f32 v14, v12, v54
    s_setprio 2
    v_fmac_f32 v19, v17, v55
    v_fmac_f32 v52, v52, v38
    v_fmac_f32 v53, v53, v43
    v_fmac_f32 v54, v54, v44
    s_waitcnt lgkmcnt(0)
    v_mul_f32 v72, v64, v56
    v_fmac_f32 v55, v55, v49
    v_fmac_f32 v4, v4, v39
    v_fmac_f32 v9, v9, v40
    v_fmac_f32 v72, v75, v154
    v_mul_f32 v73, v65, v56
    v_mul_f32 v74, v66, v58
    v_mul_f32 v75, v67, v58
    v_fmac_f32 v14, v14, v45
    v_fmac_f32 v19, v19, v50
    v_fma_f32 v60, v7, v52, v4
    v_fmac_f32 v73, v72, v155
    v_fma_f32 v61, v8, v53, v9
    v_fma_f32 v62, v13, v54, v14
    v_fma_f32 v63, v18, v55, v19
    v_fmac_f32 v74, v73, v156
    v_fmac_f32 v52, v52, v39
    v_fmac_f32 v53, v53, v40
    v_fmac_f32 v54, v54, v45
    v_fmac_f32 v75, v74, v157
    v_fmac_f32 v55, v55, v50
    v_mul_f32 v60, v60, v53
    v_mul_f32 v61, v61, v52
    v_mul_f32 v62, v62, v55
    v_mul_f32 v63, v63, v54
    v_mul_f32 v52, v52, v53
    v_mul_f32 v54, v54, v55
    v_add_f32 v80, v80, v52
    v_add_f32 v81, v81, v54
    v_and_b32 v119, v153, v118
    v_and_b32 v118, v152, v118
    v_mfma_f32_16x16x32_bf16 v[168:171], v[220:223], v[200:203], v[168:171]
    v_rcp_f32 v52, v52
    v_rcp_f32 v54, v54
    v_mfma_f32_32x32x16_bf16 v[4:19], v[92:95], v[132:135], 0
    v_exp_f32 v36, v20
    v_exp_f32 v37, v21
    v_exp_f32 v38, v22
    v_cvt_pk_bf16_f32 v76, v68, v72
    v_exp_f32 v39, v23
    v_mfma_f32_16x16x32_bf16 v[172:175], v[220:223], v[204:207], v[172:175]
    v_exp_f32 v40, v24
    v_cvt_pk_bf16_f32 v77, v69, v73
    v_exp_f32 v41, v25
    v_mfma_f32_32x32x16_bf16 v[4:19], v[96:99], v[136:139], v[4:19]
    v_exp_f32 v42, v26
    v_exp_f32 v43, v27
    v_cvt_pk_bf16_f32 v78, v70, v74
    v_exp_f32 v44, v28
    v_exp_f32 v45, v29
    v_cvt_pk_bf16_f32 v79, v71, v75
    v_mfma_f32_16x16x32_bf16 v[176:179], v[224:227], v[200:203], v[176:179]
    v_exp_f32 v46, v30
    v_exp_f32 v47, v31
    v_mfma_f32_32x32x16_bf16 v[4:19], v[116:119], v[124:127], v[4:19]
    v_exp_f32 v48, v32
    v_exp_f32 v49, v33
    v_exp_f32 v50, v34
    v_exp_f32 v51, v35
    s_setprio 0
    ds_write_b32 v88, v76
    ds_write_b32 v89, v77
    ds_write_b32 v90, v78
    ds_write_b32 v91, v79
    ds_read_b128 v[154:157], v161 offset:1040
    ds_read_b128 v[84:87], v161 offset:16
    ds_read_b32 v162, v160 offset:48
    ds_read_b64_tr_b16 v[130:131], v164
    ds_read_b96 v[120:122], v158 offset:768
    buffer_load_dwordx4 v[192:195], v2, s[28:31], s67 offen offset:2048
    buffer_load_dwordx4 v[196:199], v2, s[28:31], s68 offen offset:2048
    s_add_u32 s67, s67, 2048
    s_add_u32 s68, s68, 2048
    buffer_load_dwordx4 v[140:141], s[36:39], 0 idxen offen offset:0 lds
    buffer_load_dwordx4 v[142:143], s[40:43], 0 idxen offen offset:1024 lds
    buffer_load_dwordx4 v[144:145], s[44:47], 0 idxen offen offset:2048 lds
    buffer_load_dwordx4 v[146:147], s[48:51], 0 idxen offen offset:3072 lds
    s_sub_u32 s54, s54, 1
    v_add_f32 v56, 1.0, v36
    v_add_f32 v57, 1.0, v41
    v_add_f32 v58, 1.0, v46
    v_add_f32 v59, 1.0, v51
    v_fmac_f32 v20, v20, v37
    v_fmac_f32 v25, v25, v42
    v_fmac_f32 v30, v30, v47
    v_fmac_f32 v35, v35, v48
    v_fmac_f32 v20, v21, v56
    v_fmac_f32 v25, v26, v57
    v_fmac_f32 v30, v31, v58
    v_fmac_f32 v35, v32, v59
    v_fmac_f32 v56, v56, v37
    v_fmac_f32 v57, v57, v42
    v_fmac_f32 v58, v58, v47
    v_fmac_f32 v59, v59, v48
    v_fmac_f32 v20, v20, v38
    v_fmac_f32 v25, v25, v43
    v_fmac_f32 v30, v30, v44
    v_fmac_f32 v35, v35, v49
    v_fmac_f32 v20, v22, v56
    v_fmac_f32 v25, v27, v57
    v_fmac_f32 v30, v28, v58
    v_fmac_f32 v35, v33, v59
    v_fmac_f32 v56, v56, v38
    v_fmac_f32 v57, v57, v43
    v_fmac_f32 v58, v58, v44
    s_waitcnt lgkmcnt(0)
    v_mul_f32 v68, v60, v52
    v_fmac_f32 v59, v59, v49
    v_fmac_f32 v20, v20, v39
    v_fmac_f32 v25, v25, v40
    s_setprio 2
    v_fmac_f32 v68, v71, v154
    v_mul_f32 v69, v61, v52
    v_mul_f32 v70, v62, v54
    v_mul_f32 v71, v63, v54
    v_fmac_f32 v30, v30, v45
    v_fmac_f32 v35, v35, v50
    v_fma_f32 v64, v23, v56, v20
    v_fmac_f32 v69, v68, v155
    v_fma_f32 v65, v24, v57, v25
    v_fma_f32 v66, v29, v58, v30
    v_fma_f32 v67, v34, v59, v35
    v_fmac_f32 v70, v69, v156
    v_fmac_f32 v56, v56, v39
    v_fmac_f32 v57, v57, v40
    v_fmac_f32 v58, v58, v45
    v_fmac_f32 v71, v70, v157
    v_fmac_f32 v59, v59, v50
    v_mul_f32 v64, v64, v57
    v_mul_f32 v65, v65, v56
    v_mul_f32 v66, v66, v59
    v_mul_f32 v67, v67, v58
    v_mul_f32 v56, v56, v57
    v_mul_f32 v58, v58, v59
    v_add_f32 v80, v80, v56
    v_add_f32 v81, v81, v58
    v_xor_b32 v163, v162, v165
    v_xor_b32 v164, v162, v166
    v_add_u32 v158, 512, v158
    v_add_u32 v159, 512, v159
    v_add_u32 v160, 32, v160
    v_add_u32 v161, 32, v161
    v_add_u32 v233, 6144, v233
    v_xor_b32 v88, v84, v167
    v_xor_b32 v89, v85, v167
    v_xor_b32 v90, v86, v167
    v_xor_b32 v91, v87, v167
    s_cmp_lg_u32 s54, s69
    s_cbranch_scc1 K2_LOOPA0
    v_mfma_f32_16x16x32_bf16 v[180:183], v[224:227], v[204:207], v[180:183]
    v_mfma_f32_16x16x32_bf16 v[184:187], v[228:231], v[200:203], v[184:187]
    v_mfma_f32_16x16x32_bf16 v[188:191], v[228:231], v[204:207], v[188:191]
.p2align 3
K2_LOOP0:
    v_rcp_f32 v56, v56
    v_rcp_f32 v58, v58
    v_exp_f32 v36, v4
    v_mfma_f32_32x32x16_bf16 v[20:35], v[100:103], v[132:135], 0
    v_exp_f32 v37, v5
    v_exp_f32 v38, v6
    v_exp_f32 v39, v7
    v_exp_f32 v40, v8
    v_exp_f32 v41, v9
    v_mfma_f32_32x32x16_bf16 v[20:35], v[104:107], v[136:139], v[20:35]
    v_exp_f32 v42, v10
    v_exp_f32 v43, v11
    v_exp_f32 v44, v12
    v_exp_f32 v45, v13
    v_exp_f32 v46, v14
    v_mfma_f32_32x32x16_bf16 v[20:35], v[116:119], v[128:131], v[20:35]
    v_exp_f32 v47, v15
    v_exp_f32 v48, v16
    v_exp_f32 v49, v17
    v_exp_f32 v50, v18
    v_exp_f32 v51, v19
    s_setprio 0
    s_cmp_lt_u32 s65, 2
    s_cbranch_scc1 K2_WR0P0
    s_waitcnt vmcnt(4)
K2_WBR0P0:
    ds_read_b128 v[92:95], v148 offset:4096
    ds_read_b128 v[96:99], v149 offset:4096
    ds_read_b128 v[108:111], v150 offset:4096
    ds_read_b128 v[112:115], v151 offset:4096
    ds_read_b64_tr_b16 v[126:127], v163
    ds_read_b32 v140, v159 offset:768
    ds_read_b32 v142, v159 offset:832
    ds_read_b32 v144, v159 offset:896
    ds_read_b32 v146, v159 offset:960
    s_mov_b32 m0, s56
    v_add_f32 v52, 1.0, v36
    v_add_f32 v53, 1.0, v41
    v_add_f32 v54, 1.0, v46
    v_add_f32 v55, 1.0, v51
    v_fmac_f32 v4, v4, v37
    v_fmac_f32 v9, v9, v42
    v_fmac_f32 v14, v14, v47
    v_fmac_f32 v19, v19, v48
    v_fmac_f32 v4, v5, v52
    v_fmac_f32 v9, v10, v53
    v_fmac_f32 v14, v15, v54
    v_fmac_f32 v19, v16, v55
    v_fmac_f32 v52, v52, v37
    v_fmac_f32 v53, v53, v42
    v_fmac_f32 v54, v54, v47
    v_fmac_f32 v55, v55, v48
    v_fmac_f32 v4, v4, v38
    v_fmac_f32 v9, v9, v43
    v_fmac_f32 v14, v14, v44
    v_fmac_f32 v19, v19, v49
    v_fmac_f32 v4, v6, v52
    v_fmac_f32 v9, v11, v53
    v_fmac_f32 v14, v12, v54
    s_setprio 2
    v_fmac_f32 v19, v17, v55
    v_fmac_f32 v52, v52, v38
    v_fmac_f32 v53, v53, v43
    v_fmac_f32 v54, v54, v44
    s_waitcnt lgkmcnt(0)
    v_mul_f32 v72, v64, v56
    v_fmac_f32 v55, v55, v49
    v_fmac_f32 v4, v4, v39
    v_fmac_f32 v9, v9, v40
    v_fmac_f32 v72, v75, v154
    v_mul_f32 v73, v65, v56
    v_mul_f32 v74, v66, v58
    v_mul_f32 v75, v67, v58
    v_fmac_f32 v14, v14, v45
    v_fmac_f32 v19, v19, v50
    v_fma_f32 v60, v7, v52, v4
    v_fmac_f32 v73, v72, v155
    v_fma_f32 v61, v8, v53, v9
    v_fma_f32 v62, v13, v54, v14
    v_fma_f32 v63, v18, v55, v19
    v_fmac_f32 v74, v73, v156
    v_fmac_f32 v52, v52, v39
    v_fmac_f32 v53, v53, v40
    v_fmac_f32 v54, v54, v45
    v_fmac_f32 v75, v74, v157
    v_fmac_f32 v55, v55, v50
    v_mul_f32 v60, v60, v53
    v_mul_f32 v61, v61, v52
    v_mul_f32 v62, v62, v55
    v_mul_f32 v63, v63, v54
    v_mul_f32 v52, v52, v53
    v_mul_f32 v54, v54, v55
    v_add_f32 v80, v80, v52
    v_add_f32 v81, v81, v54
    v_and_b32 v123, v153, v122
    v_and_b32 v122, v152, v122
    v_rcp_f32 v52, v52
    v_rcp_f32 v54, v54
    v_exp_f32 v36, v20
    v_mfma_f32_32x32x16_bf16 v[4:19], v[92:95], v[132:135], 0
    v_exp_f32 v37, v21
    v_exp_f32 v38, v22
    v_cvt_pk_bf16_f32 v76, v68, v72
    v_exp_f32 v39, v23
    v_exp_f32 v40, v24
    v_cvt_pk_bf16_f32 v77, v69, v73
    v_exp_f32 v41, v25
    v_mfma_f32_32x32x16_bf16 v[4:19], v[96:99], v[136:139], v[4:19]
    v_exp_f32 v42, v26
    v_exp_f32 v43, v27
    v_cvt_pk_bf16_f32 v78, v70, v74
    v_exp_f32 v44, v28
    v_exp_f32 v45, v29
    v_cvt_pk_bf16_f32 v79, v71, v75
    v_exp_f32 v46, v30
    v_mfma_f32_32x32x16_bf16 v[4:19], v[120:123], v[124:127], v[4:19]
    v_exp_f32 v47, v31
    v_exp_f32 v48, v32
    v_exp_f32 v49, v33
    v_exp_f32 v50, v34
    v_exp_f32 v51, v35
    s_setprio 0
    ds_write_b32 v88, v76
    ds_write_b32 v89, v77
    ds_write_b32 v90, v78
    ds_write_b32 v91, v79
    ds_read_b128 v[154:157], v161 offset:1024
    ds_read_b128 v[84:87], v161 offset:0
    ds_read_b32 v162, v160 offset:32
    ds_read_b64_tr_b16 v[130:131], v164
    ds_read_b96 v[116:118], v158 offset:512
    s_cmp_le_u32 s54, 3
    s_cbranch_scc1 K2_DR0P0
    buffer_load_dwordx4 v[140:141], s[36:39], 0 idxen offen offset:0 lds
    buffer_load_dwordx4 v[142:143], s[40:43], 0 idxen offen offset:1024 lds
    buffer_load_dwordx4 v[144:145], s[44:47], 0 idxen offen offset:2048 lds
    buffer_load_dwordx4 v[146:147], s[48:51], 0 idxen offen offset:3072 lds
K2_DBR0P0:
    s_sub_u32 s54, s54, 1
    v_add_f32 v56, 1.0, v36
    v_add_f32 v57, 1.0, v41
    v_add_f32 v58, 1.0, v46
    v_add_f32 v59, 1.0, v51
    v_fmac_f32 v20, v20, v37
    v_fmac_f32 v25, v25, v42
    v_fmac_f32 v30, v30, v47
    v_fmac_f32 v35, v35, v48
    v_fmac_f32 v20, v21, v56
    v_fmac_f32 v25, v26, v57
    v_fmac_f32 v30, v31, v58
    v_fmac_f32 v35, v32, v59
    v_fmac_f32 v56, v56, v37
    v_fmac_f32 v57, v57, v42
    v_fmac_f32 v58, v58, v47
    v_fmac_f32 v59, v59, v48
    v_fmac_f32 v20, v20, v38
    v_fmac_f32 v25, v25, v43
    v_fmac_f32 v30, v30, v44
    v_fmac_f32 v35, v35, v49
    v_fmac_f32 v20, v22, v56
    v_fmac_f32 v25, v27, v57
    v_fmac_f32 v30, v28, v58
    v_fmac_f32 v35, v33, v59
    v_fmac_f32 v56, v56, v38
    v_fmac_f32 v57, v57, v43
    v_fmac_f32 v58, v58, v44
    s_setprio 2
    s_waitcnt lgkmcnt(0)
    v_mul_f32 v68, v60, v52
    v_fmac_f32 v59, v59, v49
    v_fmac_f32 v20, v20, v39
    v_fmac_f32 v25, v25, v40
    v_fmac_f32 v68, v71, v154
    v_mul_f32 v69, v61, v52
    v_mul_f32 v70, v62, v54
    v_mul_f32 v71, v63, v54
    v_fmac_f32 v30, v30, v45
    v_fmac_f32 v35, v35, v50
    v_fma_f32 v64, v23, v56, v20
    v_fmac_f32 v69, v68, v155
    v_fma_f32 v65, v24, v57, v25
    v_fma_f32 v66, v29, v58, v30
    v_fma_f32 v67, v34, v59, v35
    v_fmac_f32 v70, v69, v156
    v_fmac_f32 v56, v56, v39
    v_fmac_f32 v57, v57, v40
    v_fmac_f32 v58, v58, v45
    v_fmac_f32 v71, v70, v157
    v_fmac_f32 v59, v59, v50
    v_mul_f32 v64, v64, v57
    v_mul_f32 v65, v65, v56
    v_mul_f32 v66, v66, v59
    v_mul_f32 v67, v67, v58
    v_mul_f32 v56, v56, v57
    v_mul_f32 v58, v58, v59
    v_add_f32 v80, v80, v56
    v_add_f32 v81, v81, v58
    v_xor_b32 v163, v162, v165
    v_xor_b32 v164, v162, v166
    v_xor_b32 v88, v84, v167
    v_xor_b32 v89, v85, v167
    v_xor_b32 v90, v86, v167
    v_xor_b32 v91, v87, v167
    s_cmp_eq_u32 s54, 0
    s_cbranch_scc1 K2_X00
    v_rcp_f32 v56, v56
    v_rcp_f32 v58, v58
    v_exp_f32 v36, v4
    v_mfma_f32_32x32x16_bf16 v[20:35], v[108:111], v[132:135], 0
    v_exp_f32 v37, v5
    v_exp_f32 v38, v6
    v_exp_f32 v39, v7
    v_exp_f32 v40, v8
    v_exp_f32 v41, v9
    v_mfma_f32_32x32x16_bf16 v[20:35], v[112:115], v[136:139], v[20:35]
    v_exp_f32 v42, v10
    v_exp_f32 v43, v11
    v_exp_f32 v44, v12
    v_exp_f32 v45, v13
    v_exp_f32 v46, v14
    v_mfma_f32_32x32x16_bf16 v[20:35], v[120:123], v[128:131], v[20:35]
    v_exp_f32 v47, v15
    v_exp_f32 v48, v16
    v_exp_f32 v49, v17
    v_exp_f32 v50, v18
    v_exp_f32 v51, v19
    s_setprio 0
    s_cmp_lt_u32 s65, 2
    s_cbranch_scc1 K2_WR0P1
    s_waitcnt vmcnt(4)
K2_WBR0P1:
    ds_read_b128 v[92:95], v148 offset:0
    ds_read_b128 v[96:99], v149 offset:0
    ds_read_b128 v[100:103], v150 offset:0
    ds_read_b128 v[104:107], v151 offset:0
    ds_read_b64_tr_b16 v[126:127], v163
    ds_read_b32 v140, v159 offset:1024
    ds_read_b32 v142, v159 offset:1088
    ds_read_b32 v144, v159 offset:1152
    ds_read_b32 v146, v159 offset:1216
    s_mov_b32 m0, s55
    v_add_f32 v52, 1.0, v36
    v_add_f32 v53, 1.0, v41
    v_add_f32 v54, 1.0, v46
    v_add_f32 v55, 1.0, v51
    v_fmac_f32 v4, v4, v37
    v_fmac_f32 v9, v9, v42
    v_fmac_f32 v14, v14, v47
    v_fmac_f32 v19, v19, v48
    v_fmac_f32 v4, v5, v52
    v_fmac_f32 v9, v10, v53
    v_fmac_f32 v14, v15, v54
    v_fmac_f32 v19, v16, v55
    v_fmac_f32 v52, v52, v37
    v_fmac_f32 v53, v53, v42
    v_fmac_f32 v54, v54, v47
    v_fmac_f32 v55, v55, v48
    v_fmac_f32 v4, v4, v38
    v_fmac_f32 v9, v9, v43
    v_fmac_f32 v14, v14, v44
    v_fmac_f32 v19, v19, v49
    v_fmac_f32 v4, v6, v52
    v_fmac_f32 v9, v11, v53
    v_fmac_f32 v14, v12, v54
    s_setprio 2
    v_fmac_f32 v19, v17, v55
    v_fmac_f32 v52, v52, v38
    v_fmac_f32 v53, v53, v43
    v_fmac_f32 v54, v54, v44
    s_waitcnt lgkmcnt(0)
    v_mul_f32 v72, v64, v56
    v_fmac_f32 v55, v55, v49
    v_fmac_f32 v4, v4, v39
    v_fmac_f32 v9, v9, v40
    v_fmac_f32 v72, v75, v154
    v_mul_f32 v73, v65, v56
    v_mul_f32 v74, v66, v58
    v_mul_f32 v75, v67, v58
    v_fmac_f32 v14, v14, v45
    v_fmac_f32 v19, v19, v50
    v_fma_f32 v60, v7, v52, v4
    v_fmac_f32 v73, v72, v155
    v_fma_f32 v61, v8, v53, v9
    v_fma_f32 v62, v13, v54, v14
    v_fma_f32 v63, v18, v55, v19
    v_fmac_f32 v74, v73, v156
    v_fmac_f32 v52, v52, v39
    v_fmac_f32 v53, v53, v40
    v_fmac_f32 v54, v54, v45
    v_fmac_f32 v75, v74, v157
    v_fmac_f32 v55, v55, v50
    v_mul_f32 v60, v60, v53
    v_mul_f32 v61, v61, v52
    v_mul_f32 v62, v62, v55
    v_mul_f32 v63, v63, v54
    v_mul_f32 v52, v52, v53
    v_mul_f32 v54, v54, v55
    v_add_f32 v80, v80, v52
    v_add_f32 v81, v81, v54
    v_and_b32 v119, v153, v118
    v_and_b32 v118, v152, v118
    v_rcp_f32 v52, v52
    v_rcp_f32 v54, v54
    v_exp_f32 v36, v20
    v_mfma_f32_32x32x16_bf16 v[4:19], v[92:95], v[132:135], 0
    v_exp_f32 v37, v21
    v_exp_f32 v38, v22
    v_cvt_pk_bf16_f32 v76, v68, v72
    v_exp_f32 v39, v23
    v_exp_f32 v40, v24
    v_cvt_pk_bf16_f32 v77, v69, v73
    v_exp_f32 v41, v25
    v_mfma_f32_32x32x16_bf16 v[4:19], v[96:99], v[136:139], v[4:19]
    v_exp_f32 v42, v26
    v_exp_f32 v43, v27
    v_cvt_pk_bf16_f32 v78, v70, v74
    v_exp_f32 v44, v28
    v_exp_f32 v45, v29
    v_cvt_pk_bf16_f32 v79, v71, v75
    v_exp_f32 v46, v30
    v_mfma_f32_32x32x16_bf16 v[4:19], v[116:119], v[124:127], v[4:19]
    v_exp_f32 v47, v31
    v_exp_f32 v48, v32
    v_exp_f32 v49, v33
    v_exp_f32 v50, v34
    v_exp_f32 v51, v35
    s_setprio 0
    ds_write_b32 v88, v76
    ds_write_b32 v89, v77
    ds_write_b32 v90, v78
    ds_write_b32 v91, v79
    ds_read_b128 v[154:157], v161 offset:1040
    ds_read_b128 v[84:87], v161 offset:16
    ds_read_b32 v162, v160 offset:48
    ds_read_b64_tr_b16 v[130:131], v164
    ds_read_b96 v[120:122], v158 offset:768
    s_cmp_le_u32 s54, 3
    s_cbranch_scc1 K2_DR0P1
    buffer_load_dwordx4 v[140:141], s[36:39], 0 idxen offen offset:0 lds
    buffer_load_dwordx4 v[142:143], s[40:43], 0 idxen offen offset:1024 lds
    buffer_load_dwordx4 v[144:145], s[44:47], 0 idxen offen offset:2048 lds
    buffer_load_dwordx4 v[146:147], s[48:51], 0 idxen offen offset:3072 lds
K2_DBR0P1:
    s_sub_u32 s54, s54, 1
    v_add_f32 v56, 1.0, v36
    v_add_f32 v57, 1.0, v41
    v_add_f32 v58, 1.0, v46
    v_add_f32 v59, 1.0, v51
    v_fmac_f32 v20, v20, v37
    v_fmac_f32 v25, v25, v42
    v_fmac_f32 v30, v30, v47
    v_fmac_f32 v35, v35, v48
    v_fmac_f32 v20, v21, v56
    v_fmac_f32 v25, v26, v57
    v_fmac_f32 v30, v31, v58
    v_fmac_f32 v35, v32, v59
    v_fmac_f32 v56, v56, v37
    v_fmac_f32 v57, v57, v42
    v_fmac_f32 v58, v58, v47
    v_fmac_f32 v59, v59, v48
    v_fmac_f32 v20, v20, v38
    v_fmac_f32 v25, v25, v43
    v_fmac_f32 v30, v30, v44
    v_fmac_f32 v35, v35, v49
    v_fmac_f32 v20, v22, v56
    v_fmac_f32 v25, v27, v57
    v_fmac_f32 v30, v28, v58
    v_fmac_f32 v35, v33, v59
    v_fmac_f32 v56, v56, v38
    v_fmac_f32 v57, v57, v43
    v_fmac_f32 v58, v58, v44
    s_waitcnt lgkmcnt(0)
    v_mul_f32 v68, v60, v52
    v_fmac_f32 v59, v59, v49
    v_fmac_f32 v20, v20, v39
    s_setprio 2
    v_fmac_f32 v25, v25, v40
    v_fmac_f32 v68, v71, v154
    v_mul_f32 v69, v61, v52
    v_mul_f32 v70, v62, v54
    v_mul_f32 v71, v63, v54
    v_fmac_f32 v30, v30, v45
    v_fmac_f32 v35, v35, v50
    v_fma_f32 v64, v23, v56, v20
    v_fmac_f32 v69, v68, v155
    v_fma_f32 v65, v24, v57, v25
    v_fma_f32 v66, v29, v58, v30
    v_fma_f32 v67, v34, v59, v35
    v_fmac_f32 v70, v69, v156
    v_fmac_f32 v56, v56, v39
    v_fmac_f32 v57, v57, v40
    v_fmac_f32 v58, v58, v45
    v_fmac_f32 v71, v70, v157
    v_fmac_f32 v59, v59, v50
    v_mul_f32 v64, v64, v57
    v_mul_f32 v65, v65, v56
    v_mul_f32 v66, v66, v59
    v_mul_f32 v67, v67, v58
    v_mul_f32 v56, v56, v57
    v_mul_f32 v58, v58, v59
    v_add_f32 v80, v80, v56
    v_add_f32 v81, v81, v58
    v_xor_b32 v163, v162, v165
    v_xor_b32 v164, v162, v166
    v_add_u32 v158, 512, v158
    v_add_u32 v159, 512, v159
    v_add_u32 v160, 32, v160
    v_add_u32 v161, 32, v161
    v_xor_b32 v88, v84, v167
    v_xor_b32 v89, v85, v167
    v_xor_b32 v90, v86, v167
    v_xor_b32 v91, v87, v167
    s_cmp_eq_u32 s54, 0
    s_cbranch_scc0 K2_LOOP0
K2_X00:
    v_rcp_f32 v56, v56
    v_rcp_f32 v58, v58
    s_nop 0
    v_mul_f32 v72, v64, v56
    v_fmac_f32 v72, v75, v154
    v_mul_f32 v73, v65, v56
    v_mul_f32 v74, v66, v58
    v_mul_f32 v75, v67, v58
    v_fmac_f32 v73, v72, v155
    v_fmac_f32 v74, v73, v156
    v_fmac_f32 v75, v74, v157
    v_cvt_pk_bf16_f32 v76, v68, v72
    v_cvt_pk_bf16_f32 v77, v69, v73
    v_cvt_pk_bf16_f32 v78, v70, v74
    v_cvt_pk_bf16_f32 v79, v71, v75
    ds_write_b32 v88, v76
    ds_write_b32 v89, v77
    ds_write_b32 v90, v78
    ds_write_b32 v91, v79
    s_branch K2_TAIL
K2_R1:
    s_cmp_eq_u32 s69, 0
    s_cbranch_scc1 K2_LOOP1
.p2align 3
K2_LOOPA1:
    s_cmp_eq_u32 s65, 3
    s_cbranch_scc1 K2_F1
    s_waitcnt vmcnt(4)
K2_FB1:
    ds_read_b128 v[92:95], v148 offset:4096
    ds_read_b128 v[96:99], v149 offset:4096
    ds_read_b128 v[108:111], v150 offset:4096
    ds_read_b128 v[112:115], v151 offset:4096
    ds_read_b64_tr_b16 v[126:127], v163
    ds_read_b32 v140, v159 offset:768
    ds_read_b32 v142, v159 offset:832
    ds_read_b32 v144, v159 offset:896
    ds_read_b32 v146, v159 offset:960
    ds_read_b128 v[208:211], v232 offset:0
    ds_read_b128 v[212:215], v232 offset:2048
    ds_read_b128 v[216:219], v232 offset:4096
    ds_write_b32 v88, v76
    ds_write_b32 v89, v77
    ds_write_b32 v90, v78
    ds_write_b32 v91, v79
    s_mov_b32 m0, s56
    s_setprio 1
    v_mfma_f32_16x16x32_bf16 v[180:183], v[224:227], v[204:207], v[180:183]
    v_rcp_f32 v56, v56
    v_rcp_f32 v58, v58
    v_mfma_f32_32x32x16_bf16 v[20:35], v[100:103], v[132:135], 0
    v_exp_f32 v36, v4
    v_exp_f32 v37, v5
    v_exp_f32 v38, v6
    v_exp_f32 v39, v7
    v_mfma_f32_16x16x32_bf16 v[184:187], v[228:231], v[200:203], v[184:187]
    v_exp_f32 v40, v8
    v_exp_f32 v41, v9
    v_mfma_f32_32x32x16_bf16 v[20:35], v[104:107], v[136:139], v[20:35]
    v_exp_f32 v42, v10
    v_exp_f32 v43, v11
    v_exp_f32 v44, v12
    v_exp_f32 v45, v13
    v_mfma_f32_16x16x32_bf16 v[188:191], v[228:231], v[204:207], v[188:191]
    v_exp_f32 v46, v14
    v_exp_f32 v47, v15
    v_mfma_f32_32x32x16_bf16 v[20:35], v[116:119], v[128:131], v[20:35]
    v_exp_f32 v48, v16
    v_exp_f32 v49, v17
    v_exp_f32 v50, v18
    v_exp_f32 v51, v19
    s_setprio 3
    v_add_f32 v52, 1.0, v36
    v_add_f32 v53, 1.0, v41
    v_add_f32 v54, 1.0, v46
    v_add_f32 v55, 1.0, v51
    v_fmac_f32 v4, v4, v37
    v_fmac_f32 v9, v9, v42
    v_fmac_f32 v14, v14, v47
    v_fmac_f32 v19, v19, v48
    v_fmac_f32 v4, v5, v52
    v_fmac_f32 v9, v10, v53
    v_fmac_f32 v14, v15, v54
    v_fmac_f32 v19, v16, v55
    v_fmac_f32 v52, v52, v37
    v_fmac_f32 v53, v53, v42
    v_fmac_f32 v54, v54, v47
    v_fmac_f32 v55, v55, v48
    v_fmac_f32 v4, v4, v38
    v_fmac_f32 v9, v9, v43
    v_fmac_f32 v14, v14, v44
    v_fmac_f32 v19, v19, v49
    v_fmac_f32 v4, v6, v52
    v_fmac_f32 v9, v11, v53
    v_fmac_f32 v14, v12, v54
    v_fmac_f32 v19, v17, v55
    v_fmac_f32 v52, v52, v38
    v_fmac_f32 v53, v53, v43
    v_fmac_f32 v54, v54, v44
    s_waitcnt lgkmcnt(0)
    v_mul_f32 v72, v64, v56
    v_fmac_f32 v55, v55, v49
    v_fmac_f32 v4, v4, v39
    v_fmac_f32 v9, v9, v40
    v_fmac_f32 v72, v75, v154
    v_mul_f32 v73, v65, v56
    v_mul_f32 v74, v66, v58
    v_mul_f32 v75, v67, v58
    v_fmac_f32 v14, v14, v45
    v_fmac_f32 v19, v19, v50
    v_fma_f32 v60, v7, v52, v4
    v_fmac_f32 v73, v72, v155
    v_fma_f32 v61, v8, v53, v9
    v_fma_f32 v62, v13, v54, v14
    v_fma_f32 v63, v18, v55, v19
    v_fmac_f32 v74, v73, v156
    v_fmac_f32 v52, v52, v39
    v_fmac_f32 v53, v53, v40
    v_fmac_f32 v54, v54, v45
    v_fmac_f32 v75, v74, v157
    v_fmac_f32 v55, v55, v50
    v_mul_f32 v60, v60, v53
    v_mul_f32 v61, v61, v52
    v_mul_f32 v62, v62, v55
    v_mul_f32 v63, v63, v54
    v_mul_f32 v52, v52, v53
    v_mul_f32 v54, v54, v55
    v_add_f32 v80, v80, v52
    v_add_f32 v81, v81, v54
    v_and_b32 v123, v153, v122
    v_and_b32 v122, v152, v122
    v_xor_b32 v88, v84, v167
    v_xor_b32 v89, v85, v167
    v_xor_b32 v90, v86, v167
    v_xor_b32 v91, v87, v167
    ds_read_b128 v[154:157], v161 offset:1024
    ds_read_b128 v[84:87], v161 offset:0
    ds_read_b32 v162, v160 offset:32
    ds_read_b64_tr_b16 v[130:131], v164
    ds_read_b96 v[116:118], v158 offset:512
    buffer_load_dwordx4 v[200:203], v2, s[28:31], s67 offen offset:1024
    buffer_load_dwordx4 v[204:207], v2, s[28:31], s68 offen offset:1024
    buffer_load_dwordx4 v[140:141], s[36:39], 0 idxen offen offset:0 lds
    buffer_load_dwordx4 v[142:143], s[40:43], 0 idxen offen offset:1024 lds
    buffer_load_dwordx4 v[144:145], s[44:47], 0 idxen offen offset:2048 lds
    buffer_load_dwordx4 v[146:147], s[48:51], 0 idxen offen offset:3072 lds
    s_sub_u32 s54, s54, 1
    s_setprio 1
    v_mfma_f32_16x16x32_bf16 v[168:171], v[208:211], v[192:195], v[168:171]
    v_rcp_f32 v52, v52
    v_rcp_f32 v54, v54
    v_mfma_f32_32x32x16_bf16 v[4:19], v[92:95], v[132:135], 0
    v_exp_f32 v36, v20
    v_exp_f32 v37, v21
    v_exp_f32 v38, v22
    v_cvt_pk_bf16_f32 v76, v68, v72
    v_exp_f32 v39, v23
    v_mfma_f32_16x16x32_bf16 v[172:175], v[208:211], v[196:199], v[172:175]
    v_exp_f32 v40, v24
    v_cvt_pk_bf16_f32 v77, v69, v73
    v_exp_f32 v41, v25
    v_mfma_f32_32x32x16_bf16 v[4:19], v[96:99], v[136:139], v[4:19]
    v_exp_f32 v42, v26
    v_exp_f32 v43, v27
    v_cvt_pk_bf16_f32 v78, v70, v74
    v_exp_f32 v44, v28
    v_exp_f32 v45, v29
    v_cvt_pk_bf16_f32 v79, v71, v75
    v_mfma_f32_16x16x32_bf16 v[176:179], v[212:215], v[192:195], v[176:179]
    v_exp_f32 v46, v30
    v_exp_f32 v47, v31
    v_mfma_f32_32x32x16_bf16 v[4:19], v[120:123], v[124:127], v[4:19]
    v_exp_f32 v48, v32
    v_exp_f32 v49, v33
    v_exp_f32 v50, v34
    v_exp_f32 v51, v35
    s_setprio 3
    v_add_f32 v56, 1.0, v36
    v_add_f32 v57, 1.0, v41
    v_add_f32 v58, 1.0, v46
    v_add_f32 v59, 1.0, v51
    v_fmac_f32 v20, v20, v37
    v_fmac_f32 v25, v25, v42
    v_fmac_f32 v30, v30, v47
    v_fmac_f32 v35, v35, v48
    v_fmac_f32 v20, v21, v56
    v_fmac_f32 v25, v26, v57
    v_fmac_f32 v30, v31, v58
    v_fmac_f32 v35, v32, v59
    v_fmac_f32 v56, v56, v37
    v_fmac_f32 v57, v57, v42
    v_fmac_f32 v58, v58, v47
    v_fmac_f32 v59, v59, v48
    v_fmac_f32 v20, v20, v38
    v_fmac_f32 v25, v25, v43
    v_fmac_f32 v30, v30, v44
    v_fmac_f32 v35, v35, v49
    v_fmac_f32 v20, v22, v56
    v_fmac_f32 v25, v27, v57
    v_fmac_f32 v30, v28, v58
    v_fmac_f32 v35, v33, v59
    v_fmac_f32 v56, v56, v38
    v_fmac_f32 v57, v57, v43
    v_fmac_f32 v58, v58, v44
    s_waitcnt lgkmcnt(0)
    v_mul_f32 v68, v60, v52
    v_fmac_f32 v59, v59, v49
    v_fmac_f32 v20, v20, v39
    v_fmac_f32 v25, v25, v40
    v_fmac_f32 v68, v71, v154
    v_mul_f32 v69, v61, v52
    v_mul_f32 v70, v62, v54
    v_mul_f32 v71, v63, v54
    v_fmac_f32 v30, v30, v45
    v_fmac_f32 v35, v35, v50
    v_fma_f32 v64, v23, v56, v20
    v_fmac_f32 v69, v68, v155
    v_fma_f32 v65, v24, v57, v25
    v_fma_f32 v66, v29, v58, v30
    v_fma_f32 v67, v34, v59, v35
    v_fmac_f32 v70, v69, v156
    v_fmac_f32 v56, v56, v39
    v_fmac_f32 v57, v57, v40
    v_fmac_f32 v58, v58, v45
    v_fmac_f32 v71, v70, v157
    v_fmac_f32 v59, v59, v50
    v_mul_f32 v64, v64, v57
    v_mul_f32 v65, v65, v56
    v_mul_f32 v66, v66, v59
    v_mul_f32 v67, v67, v58
    v_mul_f32 v56, v56, v57
    v_mul_f32 v58, v58, v59
    v_add_f32 v80, v80, v56
    v_add_f32 v81, v81, v58
    v_xor_b32 v163, v162, v165
    v_xor_b32 v164, v162, v166
    v_add_u32 v232, 6144, v232
    s_waitcnt vmcnt(4)
    ds_read_b128 v[92:95], v148 offset:0
    ds_read_b128 v[96:99], v149 offset:0
    ds_read_b128 v[100:103], v150 offset:0
    ds_read_b128 v[104:107], v151 offset:0
    ds_read_b64_tr_b16 v[126:127], v163
    ds_read_b32 v140, v159 offset:1024
    ds_read_b32 v142, v159 offset:1088
    ds_read_b32 v144, v159 offset:1152
    ds_read_b32 v146, v159 offset:1216
    ds_read_b128 v[220:223], v233 offset:0
    ds_read_b128 v[224:227], v233 offset:2048
    ds_read_b128 v[228:231], v233 offset:4096
    ds_write_b32 v88, v76
    ds_write_b32 v89, v77
    ds_write_b32 v90, v78
    ds_write_b32 v91, v79
    s_mov_b32 m0, s55
    s_setprio 1
    v_mfma_f32_16x16x32_bf16 v[180:183], v[212:215], v[196:199], v[180:183]
    v_rcp_f32 v56, v56
    v_rcp_f32 v58, v58
    v_mfma_f32_32x32x16_bf16 v[20:35], v[108:111], v[132:135], 0
    v_exp_f32 v36, v4
    v_exp_f32 v37, v5
    v_exp_f32 v38, v6
    v_exp_f32 v39, v7
    v_mfma_f32_16x16x32_bf16 v[184:187], v[216:219], v[192:195], v[184:187]
    v_exp_f32 v40, v8
    v_exp_f32 v41, v9
    v_mfma_f32_32x32x16_bf16 v[20:35], v[112:115], v[136:139], v[20:35]
    v_exp_f32 v42, v10
    v_exp_f32 v43, v11
    v_exp_f32 v44, v12
    v_exp_f32 v45, v13
    v_mfma_f32_16x16x32_bf16 v[188:191], v[216:219], v[196:199], v[188:191]
    v_exp_f32 v46, v14
    v_exp_f32 v47, v15
    v_mfma_f32_32x32x16_bf16 v[20:35], v[120:123], v[128:131], v[20:35]
    v_exp_f32 v48, v16
    v_exp_f32 v49, v17
    v_exp_f32 v50, v18
    v_exp_f32 v51, v19
    s_setprio 3
    v_add_f32 v52, 1.0, v36
    v_add_f32 v53, 1.0, v41
    v_add_f32 v54, 1.0, v46
    v_add_f32 v55, 1.0, v51
    v_fmac_f32 v4, v4, v37
    v_fmac_f32 v9, v9, v42
    v_fmac_f32 v14, v14, v47
    v_fmac_f32 v19, v19, v48
    v_fmac_f32 v4, v5, v52
    v_fmac_f32 v9, v10, v53
    v_fmac_f32 v14, v15, v54
    v_fmac_f32 v19, v16, v55
    v_fmac_f32 v52, v52, v37
    v_fmac_f32 v53, v53, v42
    v_fmac_f32 v54, v54, v47
    v_fmac_f32 v55, v55, v48
    v_fmac_f32 v4, v4, v38
    v_fmac_f32 v9, v9, v43
    v_fmac_f32 v14, v14, v44
    v_fmac_f32 v19, v19, v49
    v_fmac_f32 v4, v6, v52
    v_fmac_f32 v9, v11, v53
    v_fmac_f32 v14, v12, v54
    v_fmac_f32 v19, v17, v55
    v_fmac_f32 v52, v52, v38
    v_fmac_f32 v53, v53, v43
    v_fmac_f32 v54, v54, v44
    s_waitcnt lgkmcnt(0)
    v_mul_f32 v72, v64, v56
    v_fmac_f32 v55, v55, v49
    v_fmac_f32 v4, v4, v39
    v_fmac_f32 v9, v9, v40
    v_fmac_f32 v72, v75, v154
    v_mul_f32 v73, v65, v56
    v_mul_f32 v74, v66, v58
    v_mul_f32 v75, v67, v58
    v_fmac_f32 v14, v14, v45
    v_fmac_f32 v19, v19, v50
    v_fma_f32 v60, v7, v52, v4
    v_fmac_f32 v73, v72, v155
    v_fma_f32 v61, v8, v53, v9
    v_fma_f32 v62, v13, v54, v14
    v_fma_f32 v63, v18, v55, v19
    v_fmac_f32 v74, v73, v156
    v_fmac_f32 v52, v52, v39
    v_fmac_f32 v53, v53, v40
    v_fmac_f32 v54, v54, v45
    v_fmac_f32 v75, v74, v157
    v_fmac_f32 v55, v55, v50
    v_mul_f32 v60, v60, v53
    v_mul_f32 v61, v61, v52
    v_mul_f32 v62, v62, v55
    v_mul_f32 v63, v63, v54
    v_mul_f32 v52, v52, v53
    v_mul_f32 v54, v54, v55
    v_add_f32 v80, v80, v52
    v_add_f32 v81, v81, v54
    v_and_b32 v119, v153, v118
    v_and_b32 v118, v152, v118
    v_xor_b32 v88, v84, v167
    v_xor_b32 v89, v85, v167
    v_xor_b32 v90, v86, v167
    v_xor_b32 v91, v87, v167
    ds_read_b128 v[154:157], v161 offset:1040
    ds_read_b128 v[84:87], v161 offset:16
    ds_read_b32 v162, v160 offset:48
    ds_read_b64_tr_b16 v[130:131], v164
    ds_read_b96 v[120:122], v158 offset:768
    buffer_load_dwordx4 v[192:195], v2, s[28:31], s67 offen offset:2048
    buffer_load_dwordx4 v[196:199], v2, s[28:31], s68 offen offset:2048
    s_add_u32 s67, s67, 2048
    s_add_u32 s68, s68, 2048
    buffer_load_dwordx4 v[140:141], s[36:39], 0 idxen offen offset:0 lds
    buffer_load_dwordx4 v[142:143], s[40:43], 0 idxen offen offset:1024 lds
    buffer_load_dwordx4 v[144:145], s[44:47], 0 idxen offen offset:2048 lds
    buffer_load_dwordx4 v[146:147], s[48:51], 0 idxen offen offset:3072 lds
    s_sub_u32 s54, s54, 1
    s_setprio 1
    v_mfma_f32_16x16x32_bf16 v[168:171], v[220:223], v[200:203], v[168:171]
    v_rcp_f32 v52, v52
    v_rcp_f32 v54, v54
    v_mfma_f32_32x32x16_bf16 v[4:19], v[92:95], v[132:135], 0
    v_exp_f32 v36, v20
    v_exp_f32 v37, v21
    v_exp_f32 v38, v22
    v_cvt_pk_bf16_f32 v76, v68, v72
    v_exp_f32 v39, v23
    v_mfma_f32_16x16x32_bf16 v[172:175], v[220:223], v[204:207], v[172:175]
    v_exp_f32 v40, v24
    v_cvt_pk_bf16_f32 v77, v69, v73
    v_exp_f32 v41, v25
    v_mfma_f32_32x32x16_bf16 v[4:19], v[96:99], v[136:139], v[4:19]
    v_exp_f32 v42, v26
    v_exp_f32 v43, v27
    v_cvt_pk_bf16_f32 v78, v70, v74
    v_exp_f32 v44, v28
    v_exp_f32 v45, v29
    v_cvt_pk_bf16_f32 v79, v71, v75
    v_mfma_f32_16x16x32_bf16 v[176:179], v[224:227], v[200:203], v[176:179]
    v_exp_f32 v46, v30
    v_exp_f32 v47, v31
    v_mfma_f32_32x32x16_bf16 v[4:19], v[116:119], v[124:127], v[4:19]
    v_exp_f32 v48, v32
    v_exp_f32 v49, v33
    v_exp_f32 v50, v34
    v_exp_f32 v51, v35
    s_setprio 3
    v_add_f32 v56, 1.0, v36
    v_add_f32 v57, 1.0, v41
    v_add_f32 v58, 1.0, v46
    v_add_f32 v59, 1.0, v51
    v_fmac_f32 v20, v20, v37
    v_fmac_f32 v25, v25, v42
    v_fmac_f32 v30, v30, v47
    v_fmac_f32 v35, v35, v48
    v_fmac_f32 v20, v21, v56
    v_fmac_f32 v25, v26, v57
    v_fmac_f32 v30, v31, v58
    v_fmac_f32 v35, v32, v59
    v_fmac_f32 v56, v56, v37
    v_fmac_f32 v57, v57, v42
    v_fmac_f32 v58, v58, v47
    v_fmac_f32 v59, v59, v48
    v_fmac_f32 v20, v20, v38
    v_fmac_f32 v25, v25, v43
    v_fmac_f32 v30, v30, v44
    v_fmac_f32 v35, v35, v49
    v_fmac_f32 v20, v22, v56
    v_fmac_f32 v25, v27, v57
    v_fmac_f32 v30, v28, v58
    v_fmac_f32 v35, v33, v59
    v_fmac_f32 v56, v56, v38
    v_fmac_f32 v57, v57, v43
    v_fmac_f32 v58, v58, v44
    s_waitcnt lgkmcnt(0)
    v_mul_f32 v68, v60, v52
    v_fmac_f32 v59, v59, v49
    v_fmac_f32 v20, v20, v39
    v_fmac_f32 v25, v25, v40
    v_fmac_f32 v68, v71, v154
    v_mul_f32 v69, v61, v52
    v_mul_f32 v70, v62, v54
    v_mul_f32 v71, v63, v54
    v_fmac_f32 v30, v30, v45
    v_fmac_f32 v35, v35, v50
    v_fma_f32 v64, v23, v56, v20
    v_fmac_f32 v69, v68, v155
    v_fma_f32 v65, v24, v57, v25
    v_fma_f32 v66, v29, v58, v30
    v_fma_f32 v67, v34, v59, v35
    v_fmac_f32 v70, v69, v156
    v_fmac_f32 v56, v56, v39
    v_fmac_f32 v57, v57, v40
    v_fmac_f32 v58, v58, v45
    v_fmac_f32 v71, v70, v157
    v_fmac_f32 v59, v59, v50
    v_mul_f32 v64, v64, v57
    v_mul_f32 v65, v65, v56
    v_mul_f32 v66, v66, v59
    v_mul_f32 v67, v67, v58
    v_mul_f32 v56, v56, v57
    v_mul_f32 v58, v58, v59
    v_add_f32 v80, v80, v56
    v_add_f32 v81, v81, v58
    v_xor_b32 v163, v162, v165
    v_xor_b32 v164, v162, v166
    v_add_u32 v158, 512, v158
    v_add_u32 v159, 512, v159
    v_add_u32 v160, 32, v160
    v_add_u32 v161, 32, v161
    v_add_u32 v233, 6144, v233
    s_cmp_lg_u32 s54, s69
    s_cbranch_scc1 K2_LOOPA1
    v_mfma_f32_16x16x32_bf16 v[180:183], v[224:227], v[204:207], v[180:183]
    v_mfma_f32_16x16x32_bf16 v[184:187], v[228:231], v[200:203], v[184:187]
    v_mfma_f32_16x16x32_bf16 v[188:191], v[228:231], v[204:207], v[188:191]
.p2align 3
K2_LOOP1:
    s_cmp_lt_u32 s65, 2
    s_cbranch_scc1 K2_WR1P0
    s_waitcnt vmcnt(4)
K2_WBR1P0:
    ds_read_b128 v[92:95], v148 offset:4096
    ds_read_b128 v[96:99], v149 offset:4096
    ds_read_b128 v[108:111], v150 offset:4096
    ds_read_b128 v[112:115], v151 offset:4096
    ds_read_b64_tr_b16 v[126:127], v163
    ds_read_b32 v140, v159 offset:768
    ds_read_b32 v142, v159 offset:832
    ds_read_b32 v144, v159 offset:896
    ds_read_b32 v146, v159 offset:960
    ds_write_b32 v88, v76
    ds_write_b32 v89, v77
    ds_write_b32 v90, v78
    ds_write_b32 v91, v79
    s_mov_b32 m0, s56
    s_setprio 1
    v_rcp_f32 v56, v56
    v_rcp_f32 v58, v58
    v_exp_f32 v36, v4
    v_mfma_f32_32x32x16_bf16 v[20:35], v[100:103], v[132:135], 0
    v_exp_f32 v37, v5
    v_exp_f32 v38, v6
    v_exp_f32 v39, v7
    v_exp_f32 v40, v8
    v_exp_f32 v41, v9
    v_mfma_f32_32x32x16_bf16 v[20:35], v[104:107], v[136:139], v[20:35]
    v_exp_f32 v42, v10
    v_exp_f32 v43, v11
    v_exp_f32 v44, v12
    v_exp_f32 v45, v13
    v_exp_f32 v46, v14
    v_mfma_f32_32x32x16_bf16 v[20:35], v[116:119], v[128:131], v[20:35]
    v_exp_f32 v47, v15
    v_exp_f32 v48, v16
    v_exp_f32 v49, v17
    v_exp_f32 v50, v18
    v_exp_f32 v51, v19
    s_setprio 3
    v_add_f32 v52, 1.0, v36
    v_add_f32 v53, 1.0, v41
    v_add_f32 v54, 1.0, v46
    v_add_f32 v55, 1.0, v51
    v_fmac_f32 v4, v4, v37
    v_fmac_f32 v9, v9, v42
    v_fmac_f32 v14, v14, v47
    v_fmac_f32 v19, v19, v48
    v_fmac_f32 v4, v5, v52
    v_fmac_f32 v9, v10, v53
    v_fmac_f32 v14, v15, v54
    v_fmac_f32 v19, v16, v55
    v_fmac_f32 v52, v52, v37
    v_fmac_f32 v53, v53, v42
    v_fmac_f32 v54, v54, v47
    v_fmac_f32 v55, v55, v48
    v_fmac_f32 v4, v4, v38
    v_fmac_f32 v9, v9, v43
    v_fmac_f32 v14, v14, v44
    v_fmac_f32 v19, v19, v49
    v_fmac_f32 v4, v6, v52
    v_fmac_f32 v9, v11, v53
    v_fmac_f32 v14, v12, v54
    v_fmac_f32 v19, v17, v55
    v_fmac_f32 v52, v52, v38
    v_fmac_f32 v53, v53, v43
    v_fmac_f32 v54, v54, v44
    s_waitcnt lgkmcnt(0)
    v_mul_f32 v72, v64, v56
    v_fmac_f32 v55, v55, v49
    v_fmac_f32 v4, v4, v39
    v_fmac_f32 v9, v9, v40
    v_fmac_f32 v72, v75, v154
    v_mul_f32 v73, v65, v56
    v_mul_f32 v74, v66, v58
    v_mul_f32 v75, v67, v58
    v_fmac_f32 v14, v14, v45
    v_fmac_f32 v19, v19, v50
    v_fma_f32 v60, v7, v52, v4
    v_fmac_f32 v73, v72, v155
    v_fma_f32 v61, v8, v53, v9
    v_fma_f32 v62, v13, v54, v14
    v_fma_f32 v63, v18, v55, v19
    v_fmac_f32 v74, v73, v156
    v_fmac_f32 v52, v52, v39
    v_fmac_f32 v53, v53, v40
    v_fmac_f32 v54, v54, v45
    v_fmac_f32 v75, v74, v157
    v_fmac_f32 v55, v55, v50
    v_mul_f32 v60, v60, v53
    v_mul_f32 v61, v61, v52
    v_mul_f32 v62, v62, v55
    v_mul_f32 v63, v63, v54
    v_mul_f32 v52, v52, v53
    v_mul_f32 v54, v54, v55
    v_add_f32 v80, v80, v52
    v_add_f32 v81, v81, v54
    v_and_b32 v123, v153, v122
    v_and_b32 v122, v152, v122
    v_xor_b32 v88, v84, v167
    v_xor_b32 v89, v85, v167
    v_xor_b32 v90, v86, v167
    v_xor_b32 v91, v87, v167
    ds_read_b128 v[154:157], v161 offset:1024
    ds_read_b128 v[84:87], v161 offset:0
    ds_read_b32 v162, v160 offset:32
    ds_read_b64_tr_b16 v[130:131], v164
    ds_read_b96 v[116:118], v158 offset:512
    s_cmp_le_u32 s54, 3
    s_cbranch_scc1 K2_DR1P0
    buffer_load_dwordx4 v[140:141], s[36:39], 0 idxen offen offset:0 lds
    buffer_load_dwordx4 v[142:143], s[40:43], 0 idxen offen offset:1024 lds
    buffer_load_dwordx4 v[144:145], s[44:47], 0 idxen offen offset:2048 lds
    buffer_load_dwordx4 v[146:147], s[48:51], 0 idxen offen offset:3072 lds
K2_DBR1P0:
    s_sub_u32 s54, s54, 1
    s_setprio 1
    v_rcp_f32 v52, v52
    v_rcp_f32 v54, v54
    v_exp_f32 v36, v20
    v_mfma_f32_32x32x16_bf16 v[4:19], v[92:95], v[132:135], 0
    v_exp_f32 v37, v21
    v_exp_f32 v38, v22
    v_cvt_pk_bf16_f32 v76, v68, v72
    v_exp_f32 v39, v23
    v_exp_f32 v40, v24
    v_cvt_pk_bf16_f32 v77, v69, v73
    v_exp_f32 v41, v25
    v_mfma_f32_32x32x16_bf16 v[4:19], v[96:99], v[136:139], v[4:19]
    v_exp_f32 v42, v26
    v_exp_f32 v43, v27
    v_cvt_pk_bf16_f32 v78, v70, v74
    v_exp_f32 v44, v28
    v_exp_f32 v45, v29
    v_cvt_pk_bf16_f32 v79, v71, v75
    v_exp_f32 v46, v30
    v_mfma_f32_32x32x16_bf16 v[4:19], v[120:123], v[124:127], v[4:19]
    v_exp_f32 v47, v31
    v_exp_f32 v48, v32
    v_exp_f32 v49, v33
    v_exp_f32 v50, v34
    v_exp_f32 v51, v35
    s_setprio 3
    v_add_f32 v56, 1.0, v36
    v_add_f32 v57, 1.0, v41
    v_add_f32 v58, 1.0, v46
    v_add_f32 v59, 1.0, v51
    v_fmac_f32 v20, v20, v37
    v_fmac_f32 v25, v25, v42
    v_fmac_f32 v30, v30, v47
    v_fmac_f32 v35, v35, v48
    v_fmac_f32 v20, v21, v56
    v_fmac_f32 v25, v26, v57
    v_fmac_f32 v30, v31, v58
    v_fmac_f32 v35, v32, v59
    v_fmac_f32 v56, v56, v37
    v_fmac_f32 v57, v57, v42
    v_fmac_f32 v58, v58, v47
    v_fmac_f32 v59, v59, v48
    v_fmac_f32 v20, v20, v38
    v_fmac_f32 v25, v25, v43
    v_fmac_f32 v30, v30, v44
    v_fmac_f32 v35, v35, v49
    v_fmac_f32 v20, v22, v56
    v_fmac_f32 v25, v27, v57
    v_fmac_f32 v30, v28, v58
    v_fmac_f32 v35, v33, v59
    v_fmac_f32 v56, v56, v38
    v_fmac_f32 v57, v57, v43
    v_fmac_f32 v58, v58, v44
    s_waitcnt lgkmcnt(0)
    v_mul_f32 v68, v60, v52
    v_fmac_f32 v59, v59, v49
    v_fmac_f32 v20, v20, v39
    v_fmac_f32 v25, v25, v40
    v_fmac_f32 v68, v71, v154
    v_mul_f32 v69, v61, v52
    v_mul_f32 v70, v62, v54
    v_mul_f32 v71, v63, v54
    v_fmac_f32 v30, v30, v45
    v_fmac_f32 v35, v35, v50
    v_fma_f32 v64, v23, v56, v20
    v_fmac_f32 v69, v68, v155
    v_fma_f32 v65, v24, v57, v25
    v_fma_f32 v66, v29, v58, v30
    v_fma_f32 v67, v34, v59, v35
    v_fmac_f32 v70, v69, v156
    v_fmac_f32 v56, v56, v39
    v_fmac_f32 v57, v57, v40
    v_fmac_f32 v58, v58, v45
    v_fmac_f32 v71, v70, v157
    v_fmac_f32 v59, v59, v50
    v_mul_f32 v64, v64, v57
    v_mul_f32 v65, v65, v56
    v_mul_f32 v66, v66, v59
    v_mul_f32 v67, v67, v58
    v_mul_f32 v56, v56, v57
    v_mul_f32 v58, v58, v59
    v_add_f32 v80, v80, v56
    v_add_f32 v81, v81, v58
    v_xor_b32 v163, v162, v165
    v_xor_b32 v164, v162, v166
    s_cmp_eq_u32 s54, 0
    s_cbranch_scc1 K2_X10
    s_cmp_lt_u32 s65, 2
    s_cbranch_scc1 K2_WR1P1
    s_waitcnt vmcnt(4)
K2_WBR1P1:
    ds_read_b128 v[92:95], v148 offset:0
    ds_read_b128 v[96:99], v149 offset:0
    ds_read_b128 v[100:103], v150 offset:0
    ds_read_b128 v[104:107], v151 offset:0
    ds_read_b64_tr_b16 v[126:127], v163
    ds_read_b32 v140, v159 offset:1024
    ds_read_b32 v142, v159 offset:1088
    ds_read_b32 v144, v159 offset:1152
    ds_read_b32 v146, v159 offset:1216
    ds_write_b32 v88, v76
    ds_write_b32 v89, v77
    ds_write_b32 v90, v78
    ds_write_b32 v91, v79
    s_mov_b32 m0, s55
    s_setprio 1
    v_rcp_f32 v56, v56
    v_rcp_f32 v58, v58
    v_exp_f32 v36, v4
    v_mfma_f32_32x32x16_bf16 v[20:35], v[108:111], v[132:135], 0
    v_exp_f32 v37, v5
    v_exp_f32 v38, v6
    v_exp_f32 v39, v7
    v_exp_f32 v40, v8
    v_exp_f32 v41, v9
    v_mfma_f32_32x32x16_bf16 v[20:35], v[112:115], v[136:139], v[20:35]
    v_exp_f32 v42, v10
    v_exp_f32 v43, v11
    v_exp_f32 v44, v12
    v_exp_f32 v45, v13
    v_exp_f32 v46, v14
    v_mfma_f32_32x32x16_bf16 v[20:35], v[120:123], v[128:131], v[20:35]
    v_exp_f32 v47, v15
    v_exp_f32 v48, v16
    v_exp_f32 v49, v17
    v_exp_f32 v50, v18
    v_exp_f32 v51, v19
    s_setprio 3
    v_add_f32 v52, 1.0, v36
    v_add_f32 v53, 1.0, v41
    v_add_f32 v54, 1.0, v46
    v_add_f32 v55, 1.0, v51
    v_fmac_f32 v4, v4, v37
    v_fmac_f32 v9, v9, v42
    v_fmac_f32 v14, v14, v47
    v_fmac_f32 v19, v19, v48
    v_fmac_f32 v4, v5, v52
    v_fmac_f32 v9, v10, v53
    v_fmac_f32 v14, v15, v54
    v_fmac_f32 v19, v16, v55
    v_fmac_f32 v52, v52, v37
    v_fmac_f32 v53, v53, v42
    v_fmac_f32 v54, v54, v47
    v_fmac_f32 v55, v55, v48
    v_fmac_f32 v4, v4, v38
    v_fmac_f32 v9, v9, v43
    v_fmac_f32 v14, v14, v44
    v_fmac_f32 v19, v19, v49
    v_fmac_f32 v4, v6, v52
    v_fmac_f32 v9, v11, v53
    v_fmac_f32 v14, v12, v54
    v_fmac_f32 v19, v17, v55
    v_fmac_f32 v52, v52, v38
    v_fmac_f32 v53, v53, v43
    v_fmac_f32 v54, v54, v44
    s_waitcnt lgkmcnt(0)
    v_mul_f32 v72, v64, v56
    v_fmac_f32 v55, v55, v49
    v_fmac_f32 v4, v4, v39
    v_fmac_f32 v9, v9, v40
    v_fmac_f32 v72, v75, v154
    v_mul_f32 v73, v65, v56
    v_mul_f32 v74, v66, v58
    v_mul_f32 v75, v67, v58
    v_fmac_f32 v14, v14, v45
    v_fmac_f32 v19, v19, v50
    v_fma_f32 v60, v7, v52, v4
    v_fmac_f32 v73, v72, v155
    v_fma_f32 v61, v8, v53, v9
    v_fma_f32 v62, v13, v54, v14
    v_fma_f32 v63, v18, v55, v19
    v_fmac_f32 v74, v73, v156
    v_fmac_f32 v52, v52, v39
    v_fmac_f32 v53, v53, v40
    v_fmac_f32 v54, v54, v45
    v_fmac_f32 v75, v74, v157
    v_fmac_f32 v55, v55, v50
    v_mul_f32 v60, v60, v53
    v_mul_f32 v61, v61, v52
    v_mul_f32 v62, v62, v55
    v_mul_f32 v63, v63, v54
    v_mul_f32 v52, v52, v53
    v_mul_f32 v54, v54, v55
    v_add_f32 v80, v80, v52
    v_add_f32 v81, v81, v54
    v_and_b32 v119, v153, v118
    v_and_b32 v118, v152, v118
    v_xor_b32 v88, v84, v167
    v_xor_b32 v89, v85, v167
    v_xor_b32 v90, v86, v167
    v_xor_b32 v91, v87, v167
    ds_read_b128 v[154:157], v161 offset:1040
    ds_read_b128 v[84:87], v161 offset:16
    ds_read_b32 v162, v160 offset:48
    ds_read_b64_tr_b16 v[130:131], v164
    ds_read_b96 v[120:122], v158 offset:768
    s_cmp_le_u32 s54, 3
    s_cbranch_scc1 K2_DR1P1
    buffer_load_dwordx4 v[140:141], s[36:39], 0 idxen offen offset:0 lds
    buffer_load_dwordx4 v[142:143], s[40:43], 0 idxen offen offset:1024 lds
    buffer_load_dwordx4 v[144:145], s[44:47], 0 idxen offen offset:2048 lds
    buffer_load_dwordx4 v[146:147], s[48:51], 0 idxen offen offset:3072 lds
K2_DBR1P1:
    s_sub_u32 s54, s54, 1
    s_setprio 1
    v_rcp_f32 v52, v52
    v_rcp_f32 v54, v54
    v_exp_f32 v36, v20
    v_mfma_f32_32x32x16_bf16 v[4:19], v[92:95], v[132:135], 0
    v_exp_f32 v37, v21
    v_exp_f32 v38, v22
    v_cvt_pk_bf16_f32 v76, v68, v72
    v_exp_f32 v39, v23
    v_exp_f32 v40, v24
    v_cvt_pk_bf16_f32 v77, v69, v73
    v_exp_f32 v41, v25
    v_mfma_f32_32x32x16_bf16 v[4:19], v[96:99], v[136:139], v[4:19]
    v_exp_f32 v42, v26
    v_exp_f32 v43, v27
    v_cvt_pk_bf16_f32 v78, v70, v74
    v_exp_f32 v44, v28
    v_exp_f32 v45, v29
    v_cvt_pk_bf16_f32 v79, v71, v75
    v_exp_f32 v46, v30
    v_mfma_f32_32x32x16_bf16 v[4:19], v[116:119], v[124:127], v[4:19]
    v_exp_f32 v47, v31
    v_exp_f32 v48, v32
    v_exp_f32 v49, v33
    v_exp_f32 v50, v34
    v_exp_f32 v51, v35
    s_setprio 3
    v_add_f32 v56, 1.0, v36
    v_add_f32 v57, 1.0, v41
    v_add_f32 v58, 1.0, v46
    v_add_f32 v59, 1.0, v51
    v_fmac_f32 v20, v20, v37
    v_fmac_f32 v25, v25, v42
    v_fmac_f32 v30, v30, v47
    v_fmac_f32 v35, v35, v48
    v_fmac_f32 v20, v21, v56
    v_fmac_f32 v25, v26, v57
    v_fmac_f32 v30, v31, v58
    v_fmac_f32 v35, v32, v59
    v_fmac_f32 v56, v56, v37
    v_fmac_f32 v57, v57, v42
    v_fmac_f32 v58, v58, v47
    v_fmac_f32 v59, v59, v48
    v_fmac_f32 v20, v20, v38
    v_fmac_f32 v25, v25, v43
    v_fmac_f32 v30, v30, v44
    v_fmac_f32 v35, v35, v49
    v_fmac_f32 v20, v22, v56
    v_fmac_f32 v25, v27, v57
    v_fmac_f32 v30, v28, v58
    v_fmac_f32 v35, v33, v59
    v_fmac_f32 v56, v56, v38
    v_fmac_f32 v57, v57, v43
    v_fmac_f32 v58, v58, v44
    s_waitcnt lgkmcnt(0)
    v_mul_f32 v68, v60, v52
    v_fmac_f32 v59, v59, v49
    v_fmac_f32 v20, v20, v39
    v_fmac_f32 v25, v25, v40
    v_fmac_f32 v68, v71, v154
    v_mul_f32 v69, v61, v52
    v_mul_f32 v70, v62, v54
    v_mul_f32 v71, v63, v54
    v_fmac_f32 v30, v30, v45
    v_fmac_f32 v35, v35, v50
    v_fma_f32 v64, v23, v56, v20
    v_fmac_f32 v69, v68, v155
    v_fma_f32 v65, v24, v57, v25
    v_fma_f32 v66, v29, v58, v30
    v_fma_f32 v67, v34, v59, v35
    v_fmac_f32 v70, v69, v156
    v_fmac_f32 v56, v56, v39
    v_fmac_f32 v57, v57, v40
    v_fmac_f32 v58, v58, v45
    v_fmac_f32 v71, v70, v157
    v_fmac_f32 v59, v59, v50
    v_mul_f32 v64, v64, v57
    v_mul_f32 v65, v65, v56
    v_mul_f32 v66, v66, v59
    v_mul_f32 v67, v67, v58
    v_mul_f32 v56, v56, v57
    v_mul_f32 v58, v58, v59
    v_add_f32 v80, v80, v56
    v_add_f32 v81, v81, v58
    v_xor_b32 v163, v162, v165
    v_xor_b32 v164, v162, v166
    v_add_u32 v158, 512, v158
    v_add_u32 v159, 512, v159
    v_add_u32 v160, 32, v160
    v_add_u32 v161, 32, v161
    s_cmp_eq_u32 s54, 0
    s_cbranch_scc0 K2_LOOP1
K2_X10:
    ds_write_b32 v88, v76
    ds_write_b32 v89, v77
    ds_write_b32 v90, v78
    ds_write_b32 v91, v79
    v_rcp_f32 v56, v56
    v_rcp_f32 v58, v58
    s_nop 0
    v_mul_f32 v72, v64, v56
    v_fmac_f32 v72, v75, v154
    v_mul_f32 v73, v65, v56
    v_mul_f32 v74, v66, v58
    v_mul_f32 v75, v67, v58
    v_fmac_f32 v73, v72, v155
    v_fmac_f32 v74, v73, v156
    v_fmac_f32 v75, v74, v157
    v_xor_b32 v88, v84, v167
    v_xor_b32 v89, v85, v167
    v_xor_b32 v90, v86, v167
    v_xor_b32 v91, v87, v167
    v_cvt_pk_bf16_f32 v76, v68, v72
    v_cvt_pk_bf16_f32 v77, v69, v73
    v_cvt_pk_bf16_f32 v78, v70, v74
    v_cvt_pk_bf16_f32 v79, v71, v75
    ds_write_b32 v88, v76
    ds_write_b32 v89, v77
    ds_write_b32 v90, v78
    ds_write_b32 v91, v79
K2_TAIL:
    s_setprio 0
    v_fma_f32 v80, v71, 0, v80
    v_fma_f32 v81, v75, 0, v81
    v_add_f32 v80, v80, v81
    v_mov_b32 v140, 152320
    v_cmp_ngt_f32 vcc, 0x7b800000, v80
    s_cbranch_vccnz K2_T1
K2_T1B:
    s_cmp_eq_u32 s69, 0
    s_cbranch_scc1 K2_RLATE
K2_RLATE_BACK:
    v_mov_b32 v146, 0xbfb8aa3b
    v_mov_b32 v147, 0xbfb8aa3b
    v_pk_mul_f32 v[168:169], v[168:169], v[146:147]
    v_pk_mul_f32 v[170:171], v[170:171], v[146:147]
    v_pk_mul_f32 v[172:173], v[172:173], v[146:147]
    v_pk_mul_f32 v[174:175], v[174:175], v[146:147]
    v_pk_mul_f32 v[176:177], v[176:177], v[146:147]
    v_pk_mul_f32 v[178:179], v[178:179], v[146:147]
    v_pk_mul_f32 v[180:181], v[180:181], v[146:147]
    v_pk_mul_f32 v[182:183], v[182:183], v[146:147]
    v_pk_mul_f32 v[184:185], v[184:185], v[146:147]
    v_pk_mul_f32 v[186:187], v[186:187], v[146:147]
    v_pk_mul_f32 v[188:189], v[188:189], v[146:147]
    v_pk_mul_f32 v[190:191], v[190:191], v[146:147]
    v_mov_b32 v156, v3
    v_xor_b32 v157, 64, v3
    v_xor_b32 v158, 128, v3
    v_xor_b32 v159, 192, v3
    s_movk_i32 s66, 0x2000
    s_movk_i32 s67, 0x4000
    s_cmp_eq_u32 s70, 40
    s_cselect_b32 s71, -1, 0xffff
    s_waitcnt lgkmcnt(0)
    s_barrier
    ds_read_b32 v141, v140
    s_mov_b32 exec_hi, 0xffff
    ds_read_b32 v145, v82
    ds_read_b32 v144, v83
    s_waitcnt lgkmcnt(0)
    v_lshlrev_b32 v143, 16, v145
    v_and_b32 v145, 0xffff0000, v145
    v_lshlrev_b32 v142, 16, v144
    v_and_b32 v144, 0xffff0000, v144
    v_add_f32 v143, v143, v142
    v_add_f32 v145, v145, v144
    v_cvt_pk_bf16_f32 v145, v143, v145
    ds_write_b32 v82, v145
    s_mov_b64 exec, -1
    v_readfirstlane_b32 s64, v141
    s_waitcnt lgkmcnt(0)
    s_or_b32 s82, s82, s64
    s_barrier
    s_cmp_lg_u32 s82, 0
    s_cbranch_scc1 K2_SLOW
K2_SLOW_BACK:
    ds_read_b128 v[108:111], v156 offset:0
    ds_read_b128 v[112:115], v157 offset:0
    ds_read_b128 v[116:119], v158 offset:0
    ds_read_b128 v[120:123], v159 offset:0
    ds_read_b128 v[124:127], v156 offset:256
    ds_read_b128 v[128:131], v157 offset:256
    ds_read_b128 v[132:135], v158 offset:256
    ds_read_b128 v[136:139], v159 offset:256
    s_waitcnt lgkmcnt(7)
    s_waitcnt vmcnt(0)
    v_mfma_f32_16x16x32_bf16 v[168:171], v[108:111], v[192:195], v[168:171]
    v_mfma_f32_16x16x32_bf16 v[172:175], v[108:111], v[224:227], v[172:175]
    ds_read_b128 v[108:111], v156 offset:8192
    s_waitcnt lgkmcnt(7)
    v_mfma_f32_16x16x32_bf16 v[168:171], v[112:115], v[196:199], v[168:171]
    v_mfma_f32_16x16x32_bf16 v[172:175], v[112:115], v[228:231], v[172:175]
    ds_read_b128 v[112:115], v157 offset:8192
    s_waitcnt lgkmcnt(7)
    v_mfma_f32_16x16x32_bf16 v[168:171], v[116:119], v[200:203], v[168:171]
    v_mfma_f32_16x16x32_bf16 v[172:175], v[116:119], v[232:235], v[172:175]
    ds_read_b128 v[116:119], v158 offset:8192
    s_waitcnt lgkmcnt(7)
    v_mfma_f32_16x16x32_bf16 v[168:171], v[120:123], v[204:207], v[168:171]
    v_mfma_f32_16x16x32_bf16 v[172:175], v[120:123], v[236:239], v[172:175]
    ds_read_b128 v[120:123], v159 offset:8192
    s_waitcnt lgkmcnt(7)
    v_mfma_f32_16x16x32_bf16 v[168:171], v[124:127], v[208:211], v[168:171]
    v_mfma_f32_16x16x32_bf16 v[172:175], v[124:127], v[240:243], v[172:175]
    ds_read_b128 v[124:127], v156 offset:8448
    s_waitcnt lgkmcnt(7)
    v_mfma_f32_16x16x32_bf16 v[168:171], v[128:131], v[212:215], v[168:171]
    v_mfma_f32_16x16x32_bf16 v[172:175], v[128:131], v[244:247], v[172:175]
    ds_read_b128 v[128:131], v157 offset:8448
    s_waitcnt lgkmcnt(7)
    v_mfma_f32_16x16x32_bf16 v[168:171], v[132:135], v[216:219], v[168:171]
    v_mfma_f32_16x16x32_bf16 v[172:175], v[132:135], v[248:251], v[172:175]
    ds_read_b128 v[132:135], v158 offset:8448
    s_waitcnt lgkmcnt(7)
    v_mfma_f32_16x16x32_bf16 v[168:171], v[136:139], v[220:223], v[168:171]
    v_mfma_f32_16x16x32_bf16 v[172:175], v[136:139], v[252:255], v[172:175]
    ds_read_b128 v[136:139], v159 offset:8448
    s_waitcnt lgkmcnt(7)
    v_mfma_f32_16x16x32_bf16 v[176:179], v[108:111], v[192:195], v[176:179]
    v_mfma_f32_16x16x32_bf16 v[180:183], v[108:111], v[224:227], v[180:183]
    ds_read_b128 v[108:111], v156 offset:16384
    s_waitcnt lgkmcnt(7)
    v_mfma_f32_16x16x32_bf16 v[176:179], v[112:115], v[196:199], v[176:179]
    v_mfma_f32_16x16x32_bf16 v[180:183], v[112:115], v[228:231], v[180:183]
    ds_read_b128 v[112:115], v157 offset:16384
    s_waitcnt lgkmcnt(7)
    v_mfma_f32_16x16x32_bf16 v[176:179], v[116:119], v[200:203], v[176:179]
    v_mfma_f32_16x16x32_bf16 v[180:183], v[116:119], v[232:235], v[180:183]
    ds_read_b128 v[116:119], v158 offset:16384
    v_exp_f32 v60, v168
    v_exp_f32 v61, v169
    v_exp_f32 v62, v170
    v_exp_f32 v63, v171
    v_exp_f32 v64, v172
    v_exp_f32 v65, v173
    v_exp_f32 v66, v174
    s_waitcnt lgkmcnt(7)
    v_mfma_f32_16x16x32_bf16 v[176:179], v[120:123], v[204:207], v[176:179]
    v_mfma_f32_16x16x32_bf16 v[180:183], v[120:123], v[236:239], v[180:183]
    ds_read_b128 v[120:123], v159 offset:16384
    v_exp_f32 v67, v175
    v_fma_f32 v60, v60, v146, v146
    v_fma_f32 v61, v61, v146, v146
    v_fma_f32 v62, v62, v146, v146
    v_fma_f32 v63, v63, v146, v146
    v_fma_f32 v64, v64, v146, v146
    v_fma_f32 v65, v65, v146, v146
    s_waitcnt lgkmcnt(7)
    v_mfma_f32_16x16x32_bf16 v[176:179], v[124:127], v[208:211], v[176:179]
    v_mfma_f32_16x16x32_bf16 v[180:183], v[124:127], v[240:243], v[180:183]
    ds_read_b128 v[124:127], v156 offset:16640
    v_fma_f32 v66, v66, v146, v146
    v_fma_f32 v67, v67, v146, v146
    v_rcp_f32 v60, v60
    v_rcp_f32 v61, v61
    v_rcp_f32 v62, v62
    v_rcp_f32 v63, v63
    v_rcp_f32 v64, v64
    s_waitcnt lgkmcnt(7)
    v_mfma_f32_16x16x32_bf16 v[176:179], v[128:131], v[212:215], v[176:179]
    v_mfma_f32_16x16x32_bf16 v[180:183], v[128:131], v[244:247], v[180:183]
    ds_read_b128 v[128:131], v157 offset:16640
    v_rcp_f32 v65, v65
    v_rcp_f32 v66, v66
    v_rcp_f32 v67, v67
    v_mul_f32 v168, v168, v60
    v_mul_f32 v169, v169, v61
    v_mul_f32 v170, v170, v62
    v_mul_f32 v171, v171, v63
    s_waitcnt lgkmcnt(7)
    v_mfma_f32_16x16x32_bf16 v[176:179], v[132:135], v[216:219], v[176:179]
    v_mfma_f32_16x16x32_bf16 v[180:183], v[132:135], v[248:251], v[180:183]
    ds_read_b128 v[132:135], v158 offset:16640
    v_mul_f32 v172, v172, v64
    v_mul_f32 v173, v173, v65
    v_mul_f32 v174, v174, v66
    v_mul_f32 v175, v175, v67
    v_cvt_pk_bf16_f32 v168, v168, v172
    buffer_store_dword v168, v0, s[32:35], 0 offen offset:0 sc1
    v_cvt_pk_bf16_f32 v169, v169, v173
    s_waitcnt lgkmcnt(7)
    v_mfma_f32_16x16x32_bf16 v[176:179], v[136:139], v[220:223], v[176:179]
    v_mfma_f32_16x16x32_bf16 v[180:183], v[136:139], v[252:255], v[180:183]
    ds_read_b128 v[136:139], v159 offset:16640
    buffer_store_dword v169, v0, s[32:35], 0 offen offset:512 sc1
    v_cvt_pk_bf16_f32 v170, v170, v174
    buffer_store_dword v170, v0, s[32:35], 0 offen offset:1024 sc1
    v_cvt_pk_bf16_f32 v171, v171, v175
    buffer_store_dword v171, v0, s[32:35], 0 offen offset:1536 sc1
    s_waitcnt lgkmcnt(7)
    v_mfma_f32_16x16x32_bf16 v[184:187], v[108:111], v[192:195], v[184:187]
    v_mfma_f32_16x16x32_bf16 v[188:191], v[108:111], v[224:227], v[188:191]
    s_waitcnt lgkmcnt(6)
    v_mfma_f32_16x16x32_bf16 v[184:187], v[112:115], v[196:199], v[184:187]
    v_mfma_f32_16x16x32_bf16 v[188:191], v[112:115], v[228:231], v[188:191]
    s_waitcnt lgkmcnt(5)
    v_mfma_f32_16x16x32_bf16 v[184:187], v[116:119], v[200:203], v[184:187]
    v_mfma_f32_16x16x32_bf16 v[188:191], v[116:119], v[232:235], v[188:191]
    v_exp_f32 v60, v176
    v_exp_f32 v61, v177
    v_exp_f32 v62, v178
    v_exp_f32 v63, v179
    v_exp_f32 v64, v180
    v_exp_f32 v65, v181
    v_exp_f32 v66, v182
    s_waitcnt lgkmcnt(4)
    v_mfma_f32_16x16x32_bf16 v[184:187], v[120:123], v[204:207], v[184:187]
    v_mfma_f32_16x16x32_bf16 v[188:191], v[120:123], v[236:239], v[188:191]
    v_exp_f32 v67, v183
    v_fma_f32 v60, v60, v146, v146
    v_fma_f32 v61, v61, v146, v146
    v_fma_f32 v62, v62, v146, v146
    v_fma_f32 v63, v63, v146, v146
    v_fma_f32 v64, v64, v146, v146
    v_fma_f32 v65, v65, v146, v146
    s_waitcnt lgkmcnt(3)
    v_mfma_f32_16x16x32_bf16 v[184:187], v[124:127], v[208:211], v[184:187]
    v_mfma_f32_16x16x32_bf16 v[188:191], v[124:127], v[240:243], v[188:191]
    v_fma_f32 v66, v66, v146, v146
    v_fma_f32 v67, v67, v146, v146
    v_rcp_f32 v60, v60
    v_rcp_f32 v61, v61
    v_rcp_f32 v62, v62
    v_rcp_f32 v63, v63
    v_rcp_f32 v64, v64
    s_waitcnt lgkmcnt(2)
    v_mfma_f32_16x16x32_bf16 v[184:187], v[128:131], v[212:215], v[184:187]
    v_mfma_f32_16x16x32_bf16 v[188:191], v[128:131], v[244:247], v[188:191]
    v_rcp_f32 v65, v65
    v_rcp_f32 v66, v66
    v_rcp_f32 v67, v67
    v_mul_f32 v176, v176, v60
    v_mul_f32 v177, v177, v61
    v_mul_f32 v178, v178, v62
    v_mul_f32 v179, v179, v63
    s_waitcnt lgkmcnt(1)
    v_mfma_f32_16x16x32_bf16 v[184:187], v[132:135], v[216:219], v[184:187]
    v_mfma_f32_16x16x32_bf16 v[188:191], v[132:135], v[248:251], v[188:191]
    v_mul_f32 v180, v180, v64
    v_mul_f32 v181, v181, v65
    v_mul_f32 v182, v182, v66
    v_mul_f32 v183, v183, v67
    v_cvt_pk_bf16_f32 v176, v176, v180
    buffer_store_dword v176, v0, s[32:35], s66 offen offset:0 sc1
    v_cvt_pk_bf16_f32 v177, v177, v181
    s_waitcnt lgkmcnt(0)
    v_mfma_f32_16x16x32_bf16 v[184:187], v[136:139], v[220:223], v[184:187]
    v_mfma_f32_16x16x32_bf16 v[188:191], v[136:139], v[252:255], v[188:191]
    buffer_store_dword v177, v0, s[32:35], s66 offen offset:512 sc1
    v_cvt_pk_bf16_f32 v178, v178, v182
    buffer_store_dword v178, v0, s[32:35], s66 offen offset:1024 sc1
    v_cvt_pk_bf16_f32 v179, v179, v183
    buffer_store_dword v179, v0, s[32:35], s66 offen offset:1536 sc1
    s_nop 7
    v_exp_f32 v60, v184
    v_exp_f32 v61, v185
    v_exp_f32 v62, v186
    v_exp_f32 v63, v187
    v_exp_f32 v64, v188
    v_exp_f32 v65, v189
    v_exp_f32 v66, v190
    v_exp_f32 v67, v191
    v_fma_f32 v60, v60, v146, v146
    v_fma_f32 v61, v61, v146, v146
    v_fma_f32 v62, v62, v146, v146
    v_fma_f32 v63, v63, v146, v146
    v_fma_f32 v64, v64, v146, v146
    v_fma_f32 v65, v65, v146, v146
    v_fma_f32 v66, v66, v146, v146
    v_fma_f32 v67, v67, v146, v146
    v_rcp_f32 v60, v60
    v_rcp_f32 v61, v61
    v_rcp_f32 v62, v62
    v_rcp_f32 v63, v63
    v_rcp_f32 v64, v64
    v_rcp_f32 v65, v65
    v_rcp_f32 v66, v66
    v_rcp_f32 v67, v67
    v_mul_f32 v184, v184, v60
    v_mul_f32 v185, v185, v61
    v_mul_f32 v186, v186, v62
    v_mul_f32 v187, v187, v63
    v_mul_f32 v188, v188, v64
    v_mul_f32 v189, v189, v65
    v_mul_f32 v190, v190, v66
    v_mul_f32 v191, v191, v67
    s_mov_b64 exec, 0xffffffff
    v_cvt_pk_bf16_f32 v184, v184, v188
    buffer_store_dword v184, v0, s[32:35], s67 offen offset:0 sc1
    v_cvt_pk_bf16_f32 v185, v185, v189
    buffer_store_dword v185, v0, s[32:35], s67 offen offset:512 sc1
    v_cvt_pk_bf16_f32 v186, v186, v190
    buffer_store_dword v186, v0, s[32:35], s67 offen offset:1024 sc1
    s_mov_b32 exec_lo, s71
    v_cvt_pk_bf16_f32 v187, v187, v191
    buffer_store_dword v187, v0, s[32:35], s67 offen offset:1536 sc1
K2_END:
    s_endpgm
FK_POLLMR:
    s_mov_b32 s24, s12
    s_mov_b32 s25, s13
    s_mov_b32 s26, 0x100
    s_mov_b32 s27, 0x20000
    s_mov_b64 exec, 1
    v_lshlrev_b32 v11, 7, v1
    buffer_load_dword v11, v11, s[24:27], 0 offen offset:0 sc0 sc1
    s_add_u32 s24, s14, 0xf00000
    s_addc_u32 s25, s15, 0
    s_mov_b32 s26, 0x6000
    s_mov_b32 s27, 0x20000
    s_waitcnt vmcnt(0)
    v_cmp_gt_u32 vcc, 64, v11
    s_mov_b64 exec, 1
    s_cbranch_vccnz FK_POLLBR
    s_branch FK_POLLXR
K2_S1_X:
    ds_write_b32 v92, v4 offset:256
    s_branch K2_S1_R
FK_POLLME:
    s_mov_b32 s24, s12
    s_mov_b32 s25, s13
    s_mov_b32 s26, 0x100
    s_mov_b32 s27, 0x20000
    s_mov_b64 exec, 1
    v_lshlrev_b32 v11, 7, v1
    buffer_load_dword v11, v11, s[24:27], 0 offen offset:64 sc0 sc1
    s_add_u32 s24, s14, 0xf00000
    s_addc_u32 s25, s15, 0
    s_mov_b32 s26, 0x6000
    s_mov_b32 s27, 0x20000
    s_waitcnt vmcnt(0)
    v_cmp_gt_u32 vcc, 64, v11
    s_mov_b64 exec, 4
    s_cbranch_vccnz FK_POLLBE
    s_branch FK_POLLXE
FK_POLLMP:
    s_mov_b32 s24, s12
    s_mov_b32 s25, s13
    s_mov_b32 s26, 0x100
    s_mov_b32 s27, 0x20000
    s_mov_b64 exec, 3
    v_lshlrev_b32 v11, 7, v1
    buffer_load_dword v11, v11, s[24:27], 0 offen offset:32 sc0 sc1
    s_add_u32 s24, s14, 0xf00000
    s_addc_u32 s25, s15, 0
    s_mov_b32 s26, 0x6000
    s_mov_b32 s27, 0x20000
    s_waitcnt vmcnt(0)
    v_cmp_gt_u32 vcc, 96, v11
    s_mov_b64 exec, 2
    s_cbranch_vccnz FK_POLLBP
    s_branch FK_POLLXP
K2_TOOBIG:
    s_mov_b32 s82, 1
    s_mov_b32 s54, 0
    s_mov_b32 s19, 0
    s_mov_b32 s60, 40
    s_mov_b32 s61, 40
    s_mov_b32 s62, 40
    s_mov_b64 s[66:67], 0
    s_mov_b64 s[68:69], 0
    s_mov_b64 s[70:71], 0
    s_mov_b64 s[72:73], 0
    s_mov_b64 s[74:75], 0
    s_mov_b64 s[76:77], 0
    s_mov_b64 s[78:79], 0
    s_mov_b64 s[80:81], 0
    s_branch K2_TOOBIG_BACK
FK_SIGEV:
    s_mov_b32 s16, s12
    s_mov_b32 s17, s13
    s_mov_b32 s18, 0x100
    s_mov_b32 s19, 0x20000
    s_mov_b64 exec, 1
    v_mov_b32 v7, 0
    v_mov_b32 v8, 1
    buffer_atomic_add v8, v7, s[16:19], 0 offen offset:64 sc0 sc1
    ds_write_b32 v92, v4 offset:284
    s_add_u32 s20, s14, 0xf00000
    s_addc_u32 s21, s15, 0
    s_mov_b32 s22, 0x6000
    s_mov_b32 s23, 0x20000
    s_waitcnt vmcnt(0)
    v_readfirstlane_b32 s64, v8
    s_cmp_eq_u32 s64, 63
    s_cbranch_scc0 FK_SIGE
    s_mov_b64 exec, 0xffffffff
    v_lshlrev_b32 v7, 8, v1
    v_add_u32 v7, 16384, v7
    buffer_atomic_add v4, v7, s[20:23], 0 offen sc1
FK_SIGE:
    s_mov_b64 exec, -1
    s_branch FK_SIGB
FK_OWNX:
    s_mov_b32 s24, s8
    s_mov_b32 s25, s9
    s_mov_b32 s26, 0x40800
    s_mov_b32 s27, 0x20000
    s_lshl_b32 s66, s52, 13
    s_add_u32 m0, s66, 0
    s_mov_b32 s64, 0
    buffer_load_dwordx4 v124, s[24:27], s64 offen offset:0 lds
    buffer_load_dwordx4 v125, s[24:27], s64 offen offset:1024 lds
    buffer_load_dwordx4 v126, s[24:27], s64 offen offset:2048 lds
    buffer_load_dwordx4 v127, s[24:27], s64 offen offset:3072 lds
    s_add_u32 m0, s66, 4096
    s_mov_b32 s64, 16384
    buffer_load_dwordx4 v124, s[24:27], s64 offen offset:0 lds
    buffer_load_dwordx4 v125, s[24:27], s64 offen offset:1024 lds
    buffer_load_dwordx4 v126, s[24:27], s64 offen offset:2048 lds
    buffer_load_dwordx4 v127, s[24:27], s64 offen offset:3072 lds
    s_add_u32 m0, s66, 32768
    s_mov_b32 s64, 32768
    buffer_load_dwordx4 v124, s[24:27], s64 offen offset:0 lds
    buffer_load_dwordx4 v125, s[24:27], s64 offen offset:1024 lds
    buffer_load_dwordx4 v126, s[24:27], s64 offen offset:2048 lds
    buffer_load_dwordx4 v127, s[24:27], s64 offen offset:3072 lds
    s_add_u32 m0, s66, 36864
    s_mov_b32 s64, 49152
    buffer_load_dwordx4 v124, s[24:27], s64 offen offset:0 lds
    buffer_load_dwordx4 v125, s[24:27], s64 offen offset:1024 lds
    buffer_load_dwordx4 v126, s[24:27], s64 offen offset:2048 lds
    buffer_load_dwordx4 v127, s[24:27], s64 offen offset:3072 lds
    s_waitcnt vmcnt(12)
    s_setprio 2
    ds_read_b64_tr_b16 v[60:61], v114 offset:0
    ds_read_b64_tr_b16 v[62:63], v114 offset:512
    ds_read_b64_tr_b16 v[64:65], v115 offset:0
    ds_read_b64_tr_b16 v[66:67], v115 offset:512
    ds_read_b64_tr_b16 v[68:69], v116 offset:0
    ds_read_b64_tr_b16 v[70:71], v116 offset:512
    ds_read_b64_tr_b16 v[72:73], v117 offset:0
    ds_read_b64_tr_b16 v[74:75], v117 offset:512
    ds_read_b128 v[168:171], v112 offset:0
    ds_read_b128 v[172:175], v112 offset:2048
    ds_read_b128 v[176:179], v112 offset:4096
    s_waitcnt lgkmcnt(0)
    s_waitcnt vmcnt(8)
    ds_read_b64_tr_b16 v[76:77], v114 offset:4096
    ds_read_b64_tr_b16 v[78:79], v114 offset:4608
    ds_read_b64_tr_b16 v[80:81], v115 offset:4096
    ds_read_b64_tr_b16 v[82:83], v115 offset:4608
    ds_read_b64_tr_b16 v[84:85], v116 offset:4096
    ds_read_b64_tr_b16 v[86:87], v116 offset:4608
    ds_read_b64_tr_b16 v[88:89], v117 offset:4096
    ds_read_b64_tr_b16 v[90:91], v117 offset:4608
    ds_read_b128 v[180:183], v113 offset:0
    ds_read_b128 v[184:187], v113 offset:2048
    ds_read_b128 v[188:191], v113 offset:4096
    v_mfma_f32_16x16x32_bf16 v[192:195], v[60:63], v[168:171], 0
    v_mfma_f32_16x16x32_bf16 v[196:199], v[60:63], v[172:175], 0
    v_mfma_f32_16x16x32_bf16 v[200:203], v[60:63], v[176:179], 0
    v_mfma_f32_16x16x32_bf16 v[204:207], v[68:71], v[168:171], 0
    v_mfma_f32_16x16x32_bf16 v[208:211], v[68:71], v[172:175], 0
    v_mfma_f32_16x16x32_bf16 v[212:215], v[68:71], v[176:179], 0
    v_mfma_f32_16x16x32_bf16 v[216:219], v[64:67], v[168:171], 0
    v_mfma_f32_16x16x32_bf16 v[220:223], v[64:67], v[172:175], 0
    v_mfma_f32_16x16x32_bf16 v[224:227], v[64:67], v[176:179], 0
    v_mfma_f32_16x16x32_bf16 v[228:231], v[72:75], v[168:171], 0
    v_mfma_f32_16x16x32_bf16 v[232:235], v[72:75], v[172:175], 0
    v_mfma_f32_16x16x32_bf16 v[236:239], v[72:75], v[176:179], 0
    s_waitcnt lgkmcnt(0)
    s_waitcnt vmcnt(4)
    ds_read_b64_tr_b16 v[60:61], v114 offset:32768
    ds_read_b64_tr_b16 v[62:63], v114 offset:33280
    ds_read_b64_tr_b16 v[64:65], v115 offset:32768
    ds_read_b64_tr_b16 v[66:67], v115 offset:33280
    ds_read_b64_tr_b16 v[68:69], v116 offset:32768
    ds_read_b64_tr_b16 v[70:71], v116 offset:33280
    ds_read_b64_tr_b16 v[72:73], v117 offset:32768
    ds_read_b64_tr_b16 v[74:75], v117 offset:33280
    ds_read_b128 v[168:171], v112 offset:6144
    ds_read_b128 v[172:175], v112 offset:8192
    ds_read_b128 v[176:179], v112 offset:10240
    v_mfma_f32_16x16x32_bf16 v[192:195], v[76:79], v[180:183], v[192:195]
    v_mfma_f32_16x16x32_bf16 v[196:199], v[76:79], v[184:187], v[196:199]
    v_mfma_f32_16x16x32_bf16 v[200:203], v[76:79], v[188:191], v[200:203]
    v_mfma_f32_16x16x32_bf16 v[204:207], v[84:87], v[180:183], v[204:207]
    v_mfma_f32_16x16x32_bf16 v[208:211], v[84:87], v[184:187], v[208:211]
    v_mfma_f32_16x16x32_bf16 v[212:215], v[84:87], v[188:191], v[212:215]
    v_mfma_f32_16x16x32_bf16 v[216:219], v[80:83], v[180:183], v[216:219]
    v_mfma_f32_16x16x32_bf16 v[220:223], v[80:83], v[184:187], v[220:223]
    v_mfma_f32_16x16x32_bf16 v[224:227], v[80:83], v[188:191], v[224:227]
    v_mfma_f32_16x16x32_bf16 v[228:231], v[88:91], v[180:183], v[228:231]
    v_mfma_f32_16x16x32_bf16 v[232:235], v[88:91], v[184:187], v[232:235]
    v_mfma_f32_16x16x32_bf16 v[236:239], v[88:91], v[188:191], v[236:239]
    s_waitcnt lgkmcnt(0)
    s_waitcnt vmcnt(0)
    ds_read_b64_tr_b16 v[76:77], v114 offset:36864
    ds_read_b64_tr_b16 v[78:79], v114 offset:37376
    ds_read_b64_tr_b16 v[80:81], v115 offset:36864
    ds_read_b64_tr_b16 v[82:83], v115 offset:37376
    ds_read_b64_tr_b16 v[84:85], v116 offset:36864
    ds_read_b64_tr_b16 v[86:87], v116 offset:37376
    ds_read_b64_tr_b16 v[88:89], v117 offset:36864
    ds_read_b64_tr_b16 v[90:91], v117 offset:37376
    ds_read_b128 v[180:183], v113 offset:6144
    ds_read_b128 v[184:187], v113 offset:8192
    ds_read_b128 v[188:191], v113 offset:10240
    v_mfma_f32_16x16x32_bf16 v[192:195], v[60:63], v[168:171], v[192:195]
    v_mfma_f32_16x16x32_bf16 v[196:199], v[60:63], v[172:175], v[196:199]
    v_mfma_f32_16x16x32_bf16 v[200:203], v[60:63], v[176:179], v[200:203]
    v_mfma_f32_16x16x32_bf16 v[204:207], v[68:71], v[168:171], v[204:207]
    v_mfma_f32_16x16x32_bf16 v[208:211], v[68:71], v[172:175], v[208:211]
    v_mfma_f32_16x16x32_bf16 v[212:215], v[68:71], v[176:179], v[212:215]
    v_mfma_f32_16x16x32_bf16 v[216:219], v[64:67], v[168:171], v[216:219]
    v_mfma_f32_16x16x32_bf16 v[220:223], v[64:67], v[172:175], v[220:223]
    v_mfma_f32_16x16x32_bf16 v[224:227], v[64:67], v[176:179], v[224:227]
    v_mfma_f32_16x16x32_bf16 v[228:231], v[72:75], v[168:171], v[228:231]
    v_mfma_f32_16x16x32_bf16 v[232:235], v[72:75], v[172:175], v[232:235]
    v_mfma_f32_16x16x32_bf16 v[236:239], v[72:75], v[176:179], v[236:239]
    s_waitcnt lgkmcnt(0)
    s_setprio 0
    s_branch FK_OWNX_BACK
FK_HELP:
    s_mov_b32 s79, s66
    s_lshl_b32 s66, s66, 3
    s_add_u32 s66, s66, s67
    s_cmp_ge_u32 s66, 64
    s_cbranch_scc1 FK_REP
    s_mul_i32 s64, s66, 2500
    v_add_u32 v3, s64, v0
    v_lshlrev_b32 v4, 2, v3
    v_add_u32 v12, 8192, v4
    v_lshlrev_b32 v13, 3, v3
    v_add_u32 v7, 16384, v13
    s_movk_i32 s70, 0x1000
    s_movk_i32 s71, 0x2000
    s_movk_i32 s72, 0x3000
    s_waitcnt lgkmcnt(0)
    s_mov_b64 s[4:5], s[16:17]
    s_mov_b64 s[6:7], s[18:19]
    s_mov_b64 s[36:37], s[20:21]
    s_mov_b64 s[38:39], s[22:23]
    s_mov_b64 s[8:9], s[24:25]
    s_mov_b64 s[10:11], s[26:27]
    s_mov_b64 s[40:41], s[28:29]
    s_mov_b64 s[42:43], s[30:31]
    s_mov_b64 s[12:13], s[42:43]
    s_add_u32 s20, s14, 0xf00000
    s_addc_u32 s21, s15, 0
    s_mov_b32 s22, 0x6000
    s_mov_b32 s23, 0x20000
    s_and_b32 s64, s2, 31
    s_lshl_b32 s64, s64, 8
    v_lshl_add_u32 v123, v0, 13, s64
    buffer_load_dword v122, v123, s[20:23], 0 offen sc0 sc1
    s_mov_b32 s20, s38
    s_mov_b32 s21, s39
    s_mov_b32 s22, 0x9c400
    s_mov_b32 s23, 0x20000
    buffer_load_dword v84, v4, s[20:23], 0 offen nt
    buffer_load_dword v85, v4, s[20:23], 0 offen offset:2048 nt
    buffer_load_dword v86, v4, s[20:23], s70 offen nt
    buffer_load_dword v87, v4, s[20:23], s70 offen offset:2048 nt
    buffer_load_dword v88, v12, s[20:23], 0 offen nt
    s_mov_b32 s24, s36
    s_mov_b32 s25, s37
    s_mov_b32 s26, 0x9c400
    s_mov_b32 s27, 0x20000
    buffer_load_dword v18, v4, s[24:27], 0 offen nt
    buffer_load_dword v19, v4, s[24:27], 0 offen offset:2048 nt
    buffer_load_dword v20, v4, s[24:27], s70 offen nt
    buffer_load_dword v21, v4, s[24:27], s70 offen offset:2048 nt
    buffer_load_dword v22, v12, s[24:27], 0 offen nt
    v_lshlrev_b32 v8, 4, v0
    v_add_u32 v8, 92160, v8
    v_mov_b32 v40, -1
    v_mov_b32 v41, -1
    v_mov_b32 v42, -1
    v_mov_b32 v43, -1
    ds_write_b128 v8, v[40:43] offset:0
    ds_write_b128 v8, v[40:43] offset:8192
    ds_write_b128 v8, v[40:43] offset:16384
    ds_write_b128 v8, v[40:43] offset:24576
    v_lshlrev_b32 v9, 2, v0
    v_add_u32 v9, 90112, v9
    v_mov_b32 v44, 0
    ds_write_b32 v9, v44
    v_mov_b32 v45, 1
    s_mov_b32 s73, 53687
    v_mov_b32 v39, 53686
    v_cmp_gt_u32 vcc, 452, v0
    s_mov_b64 s[74:75], vcc
    v_mov_b32 v46, -2
    v_mov_b32 v48, 90112
    v_mov_b32 v49, 92160
    s_waitcnt lgkmcnt(0)
    s_barrier
    s_waitcnt vmcnt(9)
    v_mad_u32_u24 v50, v84, s73, v39
    v_lshrrev_b32 v50, 21, v50
    v_lshl_add_u32 v47, v50, 2, v48
    ds_add_rtn_u32 v56, v47, v45
    v_mul_u32_u24 v47, 625, v50
    v_lshrrev_b32 v47, 4, v47
    v_sub_u32 v62, v84, v47
    s_waitcnt vmcnt(8)
    v_mad_u32_u24 v51, v85, s73, v39
    v_lshrrev_b32 v51, 21, v51
    v_lshl_add_u32 v47, v51, 2, v48
    ds_add_rtn_u32 v57, v47, v45
    v_mul_u32_u24 v47, 625, v51
    v_lshrrev_b32 v47, 4, v47
    v_sub_u32 v63, v85, v47
    s_waitcnt vmcnt(7)
    v_mad_u32_u24 v52, v86, s73, v39
    v_lshrrev_b32 v52, 21, v52
    v_lshl_add_u32 v47, v52, 2, v48
    ds_add_rtn_u32 v58, v47, v45
    v_mul_u32_u24 v47, 625, v52
    v_lshrrev_b32 v47, 4, v47
    v_sub_u32 v64, v86, v47
    s_waitcnt vmcnt(6)
    v_mad_u32_u24 v53, v87, s73, v39
    v_lshrrev_b32 v53, 21, v53
    v_lshl_add_u32 v47, v53, 2, v48
    ds_add_rtn_u32 v59, v47, v45
    v_mul_u32_u24 v47, 625, v53
    v_lshrrev_b32 v47, 4, v47
    v_sub_u32 v65, v87, v47
    s_waitcnt vmcnt(5)
    v_mad_u32_u24 v54, v88, s73, v39
    v_lshrrev_b32 v54, 21, v54
    v_lshl_add_u32 v47, v54, 2, v48
    s_mov_b64 exec, s[74:75]
    ds_add_rtn_u32 v60, v47, v45
    s_mov_b64 exec, -1
    v_mul_u32_u24 v47, 625, v54
    v_lshrrev_b32 v47, 4, v47
    v_sub_u32 v66, v88, v47
    s_mov_b32 s28, s6
    s_mov_b32 s29, s7
    s_mov_b32 s30, 0x138800
    s_mov_b32 s31, 0x20000
    buffer_load_dwordx2 v[100:101], v13, s[28:31], 0 offen nt
    buffer_load_dwordx2 v[102:103], v13, s[28:31], s70 offen nt
    buffer_load_dwordx2 v[104:105], v13, s[28:31], s71 offen nt
    buffer_load_dwordx2 v[106:107], v13, s[28:31], s72 offen nt
    buffer_load_dwordx2 v[108:109], v7, s[28:31], 0 offen nt
    s_waitcnt vmcnt(9) lgkmcnt(0)
    v_lshl_or_b32 v62, v62, 14, v18
    v_cmp_lt_u32 vcc, 30, v56
    v_min_u32 v56, 31, v56
    v_bfe_u32 v47, v56, 2, 2
    v_and_or_b32 v47, v56, 16, v47
    v_and_b32 v56, 3, v56
    v_lshl_add_u32 v56, v56, 2, v47
    v_lshl_add_u32 v56, v50, 5, v56
    v_cndmask_b32_e64 v62, v62, v46, vcc
    v_lshl_add_u32 v47, v56, 2, v49
    ds_write_b32 v47, v62
    v_lshlrev_b32 v56, 3, v56
    s_waitcnt vmcnt(8)
    v_lshl_or_b32 v63, v63, 14, v19
    v_cmp_lt_u32 vcc, 30, v57
    v_min_u32 v57, 31, v57
    v_bfe_u32 v47, v57, 2, 2
    v_and_or_b32 v47, v57, 16, v47
    v_and_b32 v57, 3, v57
    v_lshl_add_u32 v57, v57, 2, v47
    v_lshl_add_u32 v57, v51, 5, v57
    v_cndmask_b32_e64 v63, v63, v46, vcc
    v_lshl_add_u32 v47, v57, 2, v49
    ds_write_b32 v47, v63
    v_lshlrev_b32 v57, 3, v57
    s_waitcnt vmcnt(7)
    v_lshl_or_b32 v64, v64, 14, v20
    v_cmp_lt_u32 vcc, 30, v58
    v_min_u32 v58, 31, v58
    v_bfe_u32 v47, v58, 2, 2
    v_and_or_b32 v47, v58, 16, v47
    v_and_b32 v58, 3, v58
    v_lshl_add_u32 v58, v58, 2, v47
    v_lshl_add_u32 v58, v52, 5, v58
    v_cndmask_b32_e64 v64, v64, v46, vcc
    v_lshl_add_u32 v47, v58, 2, v49
    ds_write_b32 v47, v64
    v_lshlrev_b32 v58, 3, v58
    s_waitcnt vmcnt(6)
    v_lshl_or_b32 v65, v65, 14, v21
    v_cmp_lt_u32 vcc, 30, v59
    v_min_u32 v59, 31, v59
    v_bfe_u32 v47, v59, 2, 2
    v_and_or_b32 v47, v59, 16, v47
    v_and_b32 v59, 3, v59
    v_lshl_add_u32 v59, v59, 2, v47
    v_lshl_add_u32 v59, v53, 5, v59
    v_cndmask_b32_e64 v65, v65, v46, vcc
    v_lshl_add_u32 v47, v59, 2, v49
    ds_write_b32 v47, v65
    v_lshlrev_b32 v59, 3, v59
    s_waitcnt vmcnt(5)
    s_mov_b64 exec, s[74:75]
    v_lshl_or_b32 v66, v66, 14, v22
    v_cmp_lt_u32 vcc, 30, v60
    v_min_u32 v60, 31, v60
    v_bfe_u32 v47, v60, 2, 2
    v_and_or_b32 v47, v60, 16, v47
    v_and_b32 v60, 3, v60
    v_lshl_add_u32 v60, v60, 2, v47
    v_lshl_add_u32 v60, v54, 5, v60
    v_cndmask_b32_e64 v66, v66, v46, vcc
    v_lshl_add_u32 v47, v60, 2, v49
    ds_write_b32 v47, v66
    v_lshlrev_b32 v60, 3, v60
    s_mov_b64 exec, -1
    v_lshrrev_b32 v9, 3, v0
    v_and_b32 v12, 7, v0
    v_lshlrev_b32 v5, 13, v9
    v_lshl_add_u32 v5, v12, 4, v5
    s_lshl_b32 s64, s66, 7
    v_add_u32 v5, s64, v5
    s_add_u32 s20, s14, 0x600000
    s_addc_u32 s21, s15, 0
    s_mov_b32 s22, 0x200000
    s_mov_b32 s23, 0x20000
    s_waitcnt lgkmcnt(0)
    s_barrier
    ds_read_b128 v[68:71], v8 offset:0
    ds_read_b128 v[72:75], v8 offset:8192
    ds_read_b128 v[76:79], v8 offset:16384
    ds_read_b128 v[80:83], v8 offset:24576
    s_waitcnt lgkmcnt(3)
    buffer_store_dwordx4 v[68:71], v5, s[20:23], 0 offen sc1
    v_add_u32 v5, 0x80000, v5
    s_waitcnt lgkmcnt(2)
    buffer_store_dwordx4 v[72:75], v5, s[20:23], 0 offen sc1
    v_add_u32 v5, 0x80000, v5
    s_waitcnt lgkmcnt(1)
    buffer_store_dwordx4 v[76:79], v5, s[20:23], 0 offen sc1
    v_add_u32 v5, 0x80000, v5
    s_waitcnt lgkmcnt(0)
    buffer_store_dwordx4 v[80:83], v5, s[20:23], 0 offen sc1
    v_mov_b32 v228, 0
    v_mov_b32 v229, 0
    v_mov_b32 v230, 0
    v_mov_b32 v231, 10000
    v_lshlrev_b32 v236, 4, v0
    v_add_u32 v236, 133120, v236
    s_cmp_eq_u32 s3, 0
    s_cselect_b32 s64, 90112, 0
    s_cmp_eq_u32 s3, 1
    s_cselect_b32 s64, 131200, s64
    v_mov_b32 v232, s64
    v_mov_b32 v233, s64
    v_mov_b32 v234, s64
    v_mov_b32 v235, s64
    v_cmp_gt_u32 vcc, 240, v0
    ds_write_b128 v236, v[228:231]
    s_mov_b64 exec, vcc
    ds_write_b128 v236, v[232:235] offset:15872
    s_mov_b64 exec, -1
    v_cmp_gt_u32 vcc, 480, v0
    s_mov_b64 exec, vcc
    ds_write_b128 v236, v[228:231] offset:8192
    s_mov_b64 exec, -1
    s_waitcnt vmcnt(8)
    ds_write_b64 v56, v[100:101] offset:0
    s_waitcnt vmcnt(7)
    ds_write_b64 v57, v[102:103] offset:0
    s_waitcnt vmcnt(6)
    ds_write_b64 v58, v[104:105] offset:0
    s_waitcnt vmcnt(5)
    ds_write_b64 v59, v[106:107] offset:0
    s_waitcnt vmcnt(4)
    s_mov_b64 exec, s[74:75]
    ds_write_b64 v60, v[108:109] offset:0
    s_mov_b64 exec, -1
    v_lshlrev_b32 v13, 8, v9
    v_lshl_add_u32 v13, v12, 4, v13
    v_lshl_add_u32 v14, v9, 2, v48
    s_add_u32 s24, s14, 0x900000
    s_addc_u32 s25, s15, 0
    s_mov_b32 s26, 0x400000
    s_mov_b32 s27, 0x20000
    v_lshlrev_b32 v6, 14, v9
    v_lshl_add_u32 v6, v12, 4, v6
    s_lshl_b32 s64, s66, 8
    v_add_u32 v6, s64, v6
    s_waitcnt vmcnt(0) lgkmcnt(0)
    s_barrier
    s_cmp_eq_u32 s3, 7
    s_cbranch_scc0 FK_PR1
    v_mov_b32 v4, 1
    s_mov_b32 s16, s12
    s_mov_b32 s17, s13
    s_mov_b32 s18, 0x100
    s_mov_b32 s19, 0x20000
    s_mov_b64 exec, 1
    v_mov_b32 v7, 0
    v_mov_b32 v8, 1
    buffer_atomic_add v8, v7, s[16:19], 0 offen offset:0 sc0 sc1
    s_add_u32 s20, s14, 0xf00000
    s_addc_u32 s21, s15, 0
    s_mov_b32 s22, 0x6000
    s_mov_b32 s23, 0x20000
    s_waitcnt vmcnt(0)
    v_readfirstlane_b32 s64, v8
    s_cmp_eq_u32 s64, 63
    s_cbranch_scc0 FK_SIGR
    s_mov_b64 exec, 0xffffffff
    v_lshlrev_b32 v7, 8, v1
    v_add_u32 v7, 0, v7
    buffer_atomic_add v4, v7, s[20:23], 0 offen sc1
FK_SIGR:
    s_mov_b64 exec, -1
FK_PR1:
    ds_read_b128 v[64:67], v13 offset:0
    ds_read_b128 v[68:71], v13 offset:16384
    ds_read_b128 v[72:75], v13 offset:32768
    ds_read_b128 v[76:79], v13 offset:49152
    ds_read_b32 v80, v14 offset:0
    ds_read_b32 v81, v14 offset:256
    ds_read_b32 v82, v14 offset:512
    ds_read_b32 v83, v14 offset:768
    v_mov_b32 v15, v6
    s_waitcnt lgkmcnt(7)
    buffer_store_dwordx4 v[64:67], v6, s[24:27], 0 offen sc1
    v_add_u32 v6, 0x100000, v6
    s_waitcnt lgkmcnt(6)
    buffer_store_dwordx4 v[68:71], v6, s[24:27], 0 offen sc1
    v_add_u32 v6, 0x100000, v6
    s_waitcnt lgkmcnt(5)
    buffer_store_dwordx4 v[72:75], v6, s[24:27], 0 offen sc1
    v_add_u32 v6, 0x100000, v6
    s_waitcnt lgkmcnt(4)
    buffer_store_dwordx4 v[76:79], v6, s[24:27], 0 offen sc1
    s_waitcnt lgkmcnt(0)
    v_cmp_lt_u32 vcc, 16, v80
    s_and_saveexec_b64 s[64:65], vcc
    s_cbranch_execz FK_WP0
    ds_read_b128 v[100:103], v13 offset:128
    s_waitcnt lgkmcnt(0)
    buffer_store_dwordx4 v[100:103], v15, s[24:27], 0 offen offset:128 sc1
FK_WP0:
    s_mov_b64 exec, -1
    v_add_u32 v15, 0x100000, v15
    v_cmp_lt_u32 vcc, 16, v81
    s_and_saveexec_b64 s[64:65], vcc
    s_cbranch_execz FK_WP1
    ds_read_b128 v[104:107], v13 offset:16512
    s_waitcnt lgkmcnt(0)
    buffer_store_dwordx4 v[104:107], v15, s[24:27], 0 offen offset:128 sc1
FK_WP1:
    s_mov_b64 exec, -1
    v_add_u32 v15, 0x100000, v15
    v_cmp_lt_u32 vcc, 16, v82
    s_and_saveexec_b64 s[64:65], vcc
    s_cbranch_execz FK_WP2
    ds_read_b128 v[108:111], v13 offset:32896
    s_waitcnt lgkmcnt(0)
    buffer_store_dwordx4 v[108:111], v15, s[24:27], 0 offen offset:128 sc1
FK_WP2:
    s_mov_b64 exec, -1
    v_add_u32 v15, 0x100000, v15
    v_cmp_lt_u32 vcc, 16, v83
    s_and_saveexec_b64 s[64:65], vcc
    s_cbranch_execz FK_WP3
    ds_read_b128 v[112:115], v13 offset:49280
    s_waitcnt lgkmcnt(0)
    buffer_store_dwordx4 v[112:115], v15, s[24:27], 0 offen offset:128 sc1
FK_WP3:
    s_mov_b64 exec, -1
FK_HFIN:
    v_lshrrev_b32 v5, 5, v1
    v_and_b32 v6, 31, v1
    s_mov_b32 s16, s4
    s_mov_b32 s17, s5
    s_mov_b32 s18, 0x4e2000
    s_mov_b32 s19, 0x20000
    s_mul_i32 s65, s2, 625
    s_lshr_b32 s65, s65, 4
    s_lshl_b32 s65, s65, 9
    s_lshl_b32 s64, s52, 7
    s_add_u32 s65, s65, s64
    s_mul_i32 s64, s53, 12288
    s_add_u32 s65, s65, s64
    s_mul_i32 s67, s52, 6144
    s_mul_i32 s64, s53, 3072
    s_add_u32 s67, s67, s64
    s_lshl_b32 s64, s53, 6
    v_xor_b32 v27, s64, v27
    v_xor_b32 v28, 64, v27
    s_add_u32 m0, s67, 65536
    s_add_u32 s64, s65, 0
    buffer_load_dwordx4 v27, s[16:19], s64 offen nt lds
    s_add_u32 m0, s67, 66560
    s_add_u32 s64, s65, 4096
    buffer_load_dwordx4 v28, s[16:19], s64 offen nt lds
    s_add_u32 m0, s67, 67584
    s_add_u32 s64, s65, 8192
    buffer_load_dwordx4 v27, s[16:19], s64 offen nt lds
    s_mov_b32 s32, s40
    s_mov_b32 s33, s41
    s_mov_b32 s34, 0x4e2000
    s_mov_b32 s35, 0x20000
    s_add_u32 s28, s14, 0xe00000
    s_addc_u32 s29, s15, 0
    s_mov_b32 s30, 0x61000
    s_mov_b32 s31, 0x20000
    s_mov_b32 s36, s14
    s_mov_b32 s37, s15
    s_or_b32 s37, s37, 0x2000000
    s_mov_b32 s38, 0x4e3200
    s_mov_b32 s39, 0x20000
    s_sub_u32 s40, s14, 0x400
    s_subb_u32 s41, s15, 0
    s_or_b32 s41, s41, 0x2000000
    s_mov_b32 s42, 0x4e3200
    s_mov_b32 s43, 0x20000
    s_sub_u32 s44, s14, 0x800
    s_subb_u32 s45, s15, 0
    s_or_b32 s45, s45, 0x2000000
    s_mov_b32 s46, 0x4e3200
    s_mov_b32 s47, 0x20000
    s_sub_u32 s48, s14, 0xc00
    s_subb_u32 s49, s15, 0
    s_or_b32 s49, s49, 0x2000000
    s_mov_b32 s50, 0x4e3200
    s_mov_b32 s51, 0x20000
    v_and_b32 v15, 7, v1
    v_lshrrev_b32 v16, 4, v1
    v_xor_b32 v15, v15, v16
    s_lshl_b32 s64, s52, 7
    v_lshl_add_u32 v141, v15, 4, s64
    v_xor_b32 v143, 64, v141
    v_mov_b32 v145, v141
    v_mov_b32 v147, v143
    v_bfe_u32 v15, v1, 3, 2
    v_lshlrev_b32 v15, 4, v15
    v_add_u32 v159, 133132, v15
    v_and_b32 v15, 1, v1
    v_lshlrev_b32 v15, 4, v15
    v_mov_b32 v16, 0x3f80
    v_lshlrev_b32 v15, v15, v16
    v_lshlrev_b32 v16, 3, v5
    v_sub_u32 v16, v6, v16
    v_ashrrev_i32 v16, 1, v16
    v_cmp_eq_u32 s[16:17], 0, v16
    v_cmp_eq_u32 s[18:19], 1, v16
    v_cmp_eq_u32 s[20:21], 2, v16
    v_cmp_eq_u32 s[22:23], 3, v16
    v_cndmask_b32 v132, 0, v15, s[16:17]
    v_cndmask_b32 v133, 0, v15, s[18:19]
    v_cndmask_b32 v134, 0, v15, s[20:21]
    v_cndmask_b32 v135, 0, v15, s[22:23]
    v_cmp_eq_u32 s[16:17], 8, v16
    v_cmp_eq_u32 s[18:19], 9, v16
    v_cmp_eq_u32 s[20:21], 10, v16
    v_cmp_eq_u32 s[22:23], 11, v16
    v_cndmask_b32 v136, 0, v15, s[16:17]
    v_cndmask_b32 v137, 0, v15, s[18:19]
    v_cndmask_b32 v138, 0, v15, s[20:21]
    v_cndmask_b32 v139, 0, v15, s[22:23]
    v_lshrrev_b32 v16, 2, v6
    v_and_b32 v15, 1, v16
    v_lshlrev_b32 v15, 4, v15
    v_mov_b32 v17, 0x3f80
    v_lshlrev_b32 v15, v15, v17
    v_lshlrev_b32 v17, 2, v5
    v_sub_u32 v16, v16, v17
    v_ashrrev_i32 v16, 1, v16
    v_cmp_eq_u32 s[16:17], 0, v16
    v_cmp_eq_u32 s[18:19], 1, v16
    s_nop 0
    v_cndmask_b32 v152, 0, v15, s[16:17]
    v_cndmask_b32 v153, 0, v15, s[18:19]
    v_bfe_u32 v15, v1, 1, 3
    v_xor_b32 v15, v15, v5
    v_lshl_add_u32 v16, v6, 7, s55
    v_xor_b32 v17, 0, v15
    v_lshl_add_u32 v148, v17, 4, v16
    v_xor_b32 v17, 2, v15
    v_lshl_add_u32 v149, v17, 4, v16
    v_xor_b32 v17, 4, v15
    v_lshl_add_u32 v150, v17, 4, v16
    v_xor_b32 v17, 6, v15
    v_lshl_add_u32 v151, v17, 4, v16
    s_lshl_b32 s64, s52, 7
    v_lshl_add_u32 v167, v6, 2, s64
    v_bfe_u32 v15, v1, 4, 1
    v_lshl_add_u32 v165, v15, 5, s64
    v_and_b32 v15, 3, v1
    v_lshl_add_u32 v165, v15, 3, v165
    v_add_u32 v166, 64, v165
    v_lshrrev_b32 v15, 3, v6
    v_and_b32 v16, 3, v1
    v_lshl_add_u32 v15, v15, 2, v16
    v_lshlrev_b32 v15, 4, v15
    v_add_u32 v158, 133120, v15
    v_bfe_u32 v15, v1, 3, 1
    v_lshl_add_u32 v15, v5, 1, v15
    v_lshlrev_b32 v15, 2, v15
    v_add_u32 v160, 148992, v15
    v_mov_b32 v124, 0
    v_mov_b32 v125, 0
    v_mov_b32 v126, 0
    v_mov_b32 v127, 0
    s_cmp_eq_u32 s53, 0
    s_cbranch_scc1 FK_ES1
    v_lshrrev_b32 v7, 3, v1
    v_bfe_u32 v8, v1, 4, 1
    v_lshlrev_b32 v8, 1, v8
    v_and_b32 v9, 7, v1
    v_xor_b32 v8, v8, v9
    s_lshl_b32 s64, s52, 7
    s_add_u32 s64, s64, 131072
    v_lshl_add_u32 v7, v7, 9, s64
    v_lshl_add_u32 v124, v8, 4, v7
    v_xor_b32 v125, 64, v124
    v_add_u32 v125, 3072, v125
    v_add_u32 v126, 6144, v124
    v_add_u32 v127, 6144, v125
    s_lshl_b32 s64, s52, 13
    v_and_b32 v8, 15, v1
    v_lshrrev_b32 v9, 4, v1
    v_bfe_u32 v112, v1, 1, 3
    v_xor_b32 v9, v9, v112
    v_lshlrev_b32 v8, 7, v8
    v_add_u32 v8, 65536, v8
    v_lshl_add_u32 v112, v9, 4, v8
    v_xor_b32 v113, 64, v112
    v_lshrrev_b32 v7, 4, v1
    v_bfe_u32 v8, v1, 2, 2
    v_lshl_add_u32 v9, v7, 3, v8
    v_lshl_add_u32 v9, v9, 7, s64
    v_and_b32 v10, 3, v1
    v_lshl_add_u32 v9, v10, 3, v9
    v_and_b32 v7, 1, v7
    v_lshrrev_b32 v8, 1, v8
    v_lshl_add_u32 v7, v7, 1, v8
    v_xor_b32 v8, 0, v7
    v_lshl_add_u32 v114, v8, 5, v9
    v_xor_b32 v8, 1, v7
    v_lshl_add_u32 v115, v8, 5, v9
    v_xor_b32 v8, 2, v7
    v_lshl_add_u32 v116, v8, 5, v9
    v_xor_b32 v8, 3, v7
    v_lshl_add_u32 v117, v8, 5, v9
    v_and_b32 v8, 15, v1
    v_lshrrev_b32 v9, 4, v1
    v_bfe_u32 v10, v1, 2, 2
    v_xor_b32 v9, v9, v10
    s_lshl_b32 s64, s52, 7
    v_lshl_add_u32 v9, v9, 4, s64
    v_and_b32 v10, 3, v8
    v_lshlrev_b32 v10, 6, v10
    v_xor_b32 v9, v9, v10
    v_lshl_add_u32 v9, v8, 9, v9
    v_add_u32 v118, 90112, v9
    v_xor_b32 v119, 64, v118
FK_ES1:
    s_waitcnt vmcnt(0) lgkmcnt(0)
    s_barrier
    s_branch FK_Z
FK_REP:
    s_mov_b32 s80, 3
    s_sub_u32 s66, s66, 64
    s_lshl_b32 s66, s66, 1
    v_and_b32 v3, 15, v1
    v_lshrrev_b32 v4, 4, v1
    v_lshlrev_b32 v9, 1, v3
    s_waitcnt lgkmcnt(0)
    s_mov_b64 s[4:5], s[16:17]
    s_mov_b64 s[6:7], s[18:19]
    s_mov_b64 s[36:37], s[20:21]
    s_mov_b64 s[38:39], s[22:23]
    s_mov_b64 s[8:9], s[24:25]
    s_mov_b64 s[10:11], s[26:27]
    s_mov_b64 s[40:41], s[28:29]
    s_mov_b64 s[42:43], s[30:31]
    s_mov_b64 s[12:13], s[42:43]
    s_add_u32 s20, s14, 0xf00000
    s_addc_u32 s21, s15, 0
    s_mov_b32 s22, 0x6000
    s_mov_b32 s23, 0x20000
    s_and_b32 s64, s2, 31
    s_lshl_b32 s64, s64, 8
    v_lshl_add_u32 v123, v0, 13, s64
    buffer_load_dword v122, v123, s[20:23], 0 offen sc0 sc1
    s_cmp_eq_u32 s2, 208
    s_cbranch_scc0 FK_NOZ
    s_mov_b32 s20, s14
    s_mov_b32 s21, s15
    s_mov_b32 s22, 0x4e2200
    s_mov_b32 s23, 0x20000
    v_lshlrev_b32 v7, 2, v0
    v_add_u32 v7, 5120000, v7
    v_mov_b32 v8, 0
    buffer_store_dword v8, v7, s[20:23], 0 offen sc1
    s_mov_b32 s20, s8
    s_mov_b32 s21, s9
    s_mov_b32 s22, 0x40800
    s_mov_b32 s23, 0x20000
    s_add_u32 s24, s14, 0xe00000
    s_addc_u32 s25, s15, 0
    s_mov_b32 s26, 0x61000
    s_mov_b32 s27, 0x20000
    v_lshrrev_b32 v7, 7, v0
    v_bfe_u32 v8, v0, 6, 1
    v_and_b32 v10, 1, v0
    v_bfe_u32 v11, v0, 1, 4
    v_lshl_add_u32 v11, v7, 6, v11
    v_lshl_add_u32 v11, v10, 5, v11
    v_lshl_add_u32 v11, v8, 4, v11
    v_lshlrev_b32 v11, 1, v11
    v_add_u32 v11, 262144, v11
    buffer_load_ushort v50, v11, s[20:23], 0 offen offset:0
    buffer_load_ushort v51, v11, s[20:23], 0 offen offset:512
    buffer_load_ushort v52, v11, s[20:23], 0 offen offset:1024
    buffer_load_ushort v53, v11, s[20:23], 0 offen offset:1536
    v_cmp_lt_u32 vcc, 31, v1
    s_waitcnt vmcnt(0)
    v_lshlrev_b32 v50, 16, v50
    v_mul_f32 v50, 0xbfb8aa3b, v50
    v_lshlrev_b32 v51, 16, v51
    v_mul_f32 v51, 0xbfb8aa3b, v51
    v_lshlrev_b32 v52, 16, v52
    v_mul_f32 v52, 0xbfb8aa3b, v52
    v_lshlrev_b32 v53, 16, v53
    v_mul_f32 v53, 0xbfb8aa3b, v53
    v_cvt_pk_bf16_f32 v54, v50, v51
    v_cvt_pk_bf16_f32 v55, v52, v53
    v_lshlrev_b32 v56, 16, v54
    v_and_b32 v57, 0xffff0000, v54
    v_lshlrev_b32 v58, 16, v55
    v_and_b32 v59, 0xffff0000, v55
    v_sub_f32 v50, v50, v56
    v_sub_f32 v51, v51, v57
    v_sub_f32 v52, v52, v58
    v_sub_f32 v53, v53, v59
    v_cvt_pk_bf16_f32 v56, v50, v51
    v_cvt_pk_bf16_f32 v57, v52, v53
    v_cndmask_b32_e64 v54, v54, v56, vcc
    v_cndmask_b32_e64 v55, v55, v57, vcc
    v_lshlrev_b32 v7, 3, v0
    v_add_u32 v7, 393216, v7
    buffer_store_dwordx2 v[54:55], v7, s[24:27], 0 offen sc1
FK_NOZ:
    s_mov_b32 s20, s10
    s_mov_b32 s21, s11
    s_mov_b32 s22, 0x40000
    s_mov_b32 s23, 0x20000
    s_add_u32 s24, s14, 0xe00000
    s_addc_u32 s25, s15, 0
    s_mov_b32 s26, 0x61000
    s_mov_b32 s27, 0x20000
    s_lshr_b32 s69, s66, 4
    s_bfe_u32 s70, s66, 0x30001
    s_lshl_b32 s70, s70, 5
    v_add_u32 v8, s70, v9
    s_lshl_b32 s71, s3, 5
    s_lshr_b32 s72, s3, 1
    s_lshl_b32 s72, s72, 6
    s_and_b32 s73, s3, 1
    s_lshl_b32 s73, s73, 3
    s_add_u32 s72, s72, s73
    s_add_u32 s72, s72, 0x100
    s_cmp_eq_u32 s69, 1
    s_cselect_b32 s71, s72, s71
    s_cselect_b32 s73, 1, 3
    s_movk_i32 s72, 512
    s_cselect_b32 s45, 8192, s72
    s_movk_i32 s72, 1024
    s_cselect_b32 s46, 16384, s72
    s_movk_i32 s72, 1536
    s_cselect_b32 s47, 24576, s72
    s_movk_i32 s72, 2048
    s_cselect_b32 s48, 512, s72
    s_movk_i32 s72, 2560
    s_cselect_b32 s49, 8704, s72
    s_movk_i32 s72, 3072
    s_cselect_b32 s50, 16896, s72
    s_movk_i32 s72, 3584
    s_cselect_b32 s51, 25088, s72
    v_lshlrev_b32 v7, s73, v4
    v_add_u32 v7, s71, v7
    v_lshlrev_b32 v7, 9, v7
    v_lshl_add_u32 v7, v8, 1, v7
    buffer_load_dword v30, v7, s[20:23], 0 offen
    buffer_load_dword v31, v7, s[20:23], s45 offen
    buffer_load_dword v32, v7, s[20:23], s46 offen
    buffer_load_dword v33, v7, s[20:23], s47 offen
    buffer_load_dword v34, v7, s[20:23], s48 offen
    buffer_load_dword v35, v7, s[20:23], s49 offen
    buffer_load_dword v36, v7, s[20:23], s50 offen
    buffer_load_dword v37, v7, s[20:23], s51 offen
    v_mov_b32 v228, 0
    v_mov_b32 v229, 0
    v_mov_b32 v230, 0
    v_mov_b32 v231, 10000
    v_lshlrev_b32 v236, 4, v0
    v_add_u32 v236, 133120, v236
    s_cmp_eq_u32 s3, 0
    s_cselect_b32 s64, 90112, 0
    s_cmp_eq_u32 s3, 1
    s_cselect_b32 s64, 131200, s64
    v_mov_b32 v232, s64
    v_mov_b32 v233, s64
    v_mov_b32 v234, s64
    v_mov_b32 v235, s64
    v_cmp_gt_u32 vcc, 240, v0
    ds_write_b128 v236, v[228:231]
    s_mov_b64 exec, vcc
    ds_write_b128 v236, v[232:235] offset:15872
    s_mov_b64 exec, -1
    v_cmp_gt_u32 vcc, 480, v0
    s_mov_b64 exec, vcc
    ds_write_b128 v236, v[228:231] offset:8192
    s_mov_b64 exec, -1
    s_lshl_b32 s64, s66, 13
    s_add_u32 s64, s64, 131072
    s_lshl_b32 s65, s3, 10
    s_add_u32 s64, s64, s65
    v_add_u32 v7, s64, v2
    v_add_u32 v8, 8192, v7
    s_waitcnt vmcnt(0)
    s_mov_b32 s64, 0x05040100
    s_mov_b32 s65, 0x07060302
    v_perm_b32 v40, v31, v30, s64
    v_perm_b32 v41, v33, v32, s64
    v_perm_b32 v42, v35, v34, s64
    v_perm_b32 v43, v37, v36, s64
    v_perm_b32 v44, v31, v30, s65
    v_perm_b32 v45, v33, v32, s65
    v_perm_b32 v46, v35, v34, s65
    v_perm_b32 v47, v37, v36, s65
    buffer_store_dwordx4 v[40:43], v7, s[24:27], 0 offen sc1
    buffer_store_dwordx4 v[44:47], v8, s[24:27], 0 offen sc1
    s_branch FK_HFIN
K2_FEW:
    s_waitcnt vmcnt(0)
    s_mov_b32 s65, 0
    s_add_u32 s64, s63, 262144
    buffer_load_dwordx4 v[192:195], v2, s[28:31], s64 offen offset:0
    buffer_load_dwordx4 v[196:199], v2, s[28:31], s64 offen offset:1024
    buffer_load_dwordx4 v[200:203], v2, s[28:31], s64 offen offset:2048
    buffer_load_dwordx4 v[204:207], v2, s[28:31], s64 offen offset:3072
    s_add_u32 s64, s63, 266240
    buffer_load_dwordx4 v[208:211], v2, s[28:31], s64 offen offset:0
    buffer_load_dwordx4 v[212:215], v2, s[28:31], s64 offen offset:1024
    buffer_load_dwordx4 v[216:219], v2, s[28:31], s64 offen offset:2048
    buffer_load_dwordx4 v[220:223], v2, s[28:31], s64 offen offset:3072
    s_add_u32 s64, s63, 270336
    buffer_load_dwordx4 v[224:227], v2, s[28:31], s64 offen offset:0
    buffer_load_dwordx4 v[228:231], v2, s[28:31], s64 offen offset:1024
    buffer_load_dwordx4 v[232:235], v2, s[28:31], s64 offen offset:2048
    buffer_load_dwordx4 v[236:239], v2, s[28:31], s64 offen offset:3072
    s_add_u32 s64, s63, 274432
    buffer_load_dwordx4 v[240:243], v2, s[28:31], s64 offen offset:0
    buffer_load_dwordx4 v[244:247], v2, s[28:31], s64 offen offset:1024
    buffer_load_dwordx4 v[248:251], v2, s[28:31], s64 offen offset:2048
    buffer_load_dwordx4 v[252:255], v2, s[28:31], s64 offen offset:3072
    s_branch K2_FEW_BACK
K2_F0:
    s_mov_b32 s65, 2
    buffer_load_dwordx4 v[140:141], s[36:39], 0 idxen offen offset:0 lds
    buffer_load_dwordx4 v[142:143], s[40:43], 0 idxen offen offset:1024 lds
    buffer_load_dwordx4 v[144:145], s[44:47], 0 idxen offen offset:2048 lds
    buffer_load_dwordx4 v[146:147], s[48:51], 0 idxen offen offset:3072 lds
    s_waitcnt vmcnt(4)
    s_branch K2_FB0
K2_WR0P0:
    s_waitcnt vmcnt(8)
    s_branch K2_WBR0P0
K2_DR0P0:
    s_cmp_eq_u32 s65, 2
    s_cbranch_scc0 K2_ER0P0
    s_mov_b32 s65, 1
    s_add_u32 s64, s63, 262144
    buffer_load_dwordx4 v[192:195], v2, s[28:31], s64 offen offset:0
    buffer_load_dwordx4 v[196:199], v2, s[28:31], s64 offen offset:1024
    buffer_load_dwordx4 v[200:203], v2, s[28:31], s64 offen offset:2048
    buffer_load_dwordx4 v[204:207], v2, s[28:31], s64 offen offset:3072
    s_add_u32 s64, s63, 270336
    buffer_load_dwordx4 v[224:227], v2, s[28:31], s64 offen offset:0
    buffer_load_dwordx4 v[228:231], v2, s[28:31], s64 offen offset:1024
    buffer_load_dwordx4 v[232:235], v2, s[28:31], s64 offen offset:2048
    buffer_load_dwordx4 v[236:239], v2, s[28:31], s64 offen offset:3072
    s_branch K2_DBR0P0
K2_ER0P0:
    s_cmp_eq_u32 s65, 1
    s_cbranch_scc0 K2_DBR0P0
    s_mov_b32 s65, 0
    s_add_u32 s64, s63, 266240
    buffer_load_dwordx4 v[208:211], v2, s[28:31], s64 offen offset:0
    buffer_load_dwordx4 v[212:215], v2, s[28:31], s64 offen offset:1024
    buffer_load_dwordx4 v[216:219], v2, s[28:31], s64 offen offset:2048
    buffer_load_dwordx4 v[220:223], v2, s[28:31], s64 offen offset:3072
    s_add_u32 s64, s63, 274432
    buffer_load_dwordx4 v[240:243], v2, s[28:31], s64 offen offset:0
    buffer_load_dwordx4 v[244:247], v2, s[28:31], s64 offen offset:1024
    buffer_load_dwordx4 v[248:251], v2, s[28:31], s64 offen offset:2048
    buffer_load_dwordx4 v[252:255], v2, s[28:31], s64 offen offset:3072
    s_branch K2_DBR0P0
K2_WR0P1:
    s_waitcnt vmcnt(8)
    s_branch K2_WBR0P1
K2_DR0P1:
    s_cmp_eq_u32 s65, 2
    s_cbranch_scc0 K2_ER0P1
    s_mov_b32 s65, 1
    s_add_u32 s64, s63, 262144
    buffer_load_dwordx4 v[192:195], v2, s[28:31], s64 offen offset:0
    buffer_load_dwordx4 v[196:199], v2, s[28:31], s64 offen offset:1024
    buffer_load_dwordx4 v[200:203], v2, s[28:31], s64 offen offset:2048
    buffer_load_dwordx4 v[204:207], v2, s[28:31], s64 offen offset:3072
    s_add_u32 s64, s63, 270336
    buffer_load_dwordx4 v[224:227], v2, s[28:31], s64 offen offset:0
    buffer_load_dwordx4 v[228:231], v2, s[28:31], s64 offen offset:1024
    buffer_load_dwordx4 v[232:235], v2, s[28:31], s64 offen offset:2048
    buffer_load_dwordx4 v[236:239], v2, s[28:31], s64 offen offset:3072
    s_branch K2_DBR0P1
K2_ER0P1:
    s_cmp_eq_u32 s65, 1
    s_cbranch_scc0 K2_DBR0P1
    s_mov_b32 s65, 0
    s_add_u32 s64, s63, 266240
    buffer_load_dwordx4 v[208:211], v2, s[28:31], s64 offen offset:0
    buffer_load_dwordx4 v[212:215], v2, s[28:31], s64 offen offset:1024
    buffer_load_dwordx4 v[216:219], v2, s[28:31], s64 offen offset:2048
    buffer_load_dwordx4 v[220:223], v2, s[28:31], s64 offen offset:3072
    s_add_u32 s64, s63, 274432
    buffer_load_dwordx4 v[240:243], v2, s[28:31], s64 offen offset:0
    buffer_load_dwordx4 v[244:247], v2, s[28:31], s64 offen offset:1024
    buffer_load_dwordx4 v[248:251], v2, s[28:31], s64 offen offset:2048
    buffer_load_dwordx4 v[252:255], v2, s[28:31], s64 offen offset:3072
    s_branch K2_DBR0P1
K2_F1:
    s_mov_b32 s65, 2
    buffer_load_dwordx4 v[140:141], s[36:39], 0 idxen offen offset:0 lds
    buffer_load_dwordx4 v[142:143], s[40:43], 0 idxen offen offset:1024 lds
    buffer_load_dwordx4 v[144:145], s[44:47], 0 idxen offen offset:2048 lds
    buffer_load_dwordx4 v[146:147], s[48:51], 0 idxen offen offset:3072 lds
    s_waitcnt vmcnt(4)
    s_branch K2_FB1
K2_WR1P0:
    s_waitcnt vmcnt(8)
    s_branch K2_WBR1P0
K2_DR1P0:
    s_cmp_eq_u32 s65, 2
    s_cbranch_scc0 K2_ER1P0
    s_mov_b32 s65, 1
    s_add_u32 s64, s63, 262144
    buffer_load_dwordx4 v[192:195], v2, s[28:31], s64 offen offset:0
    buffer_load_dwordx4 v[196:199], v2, s[28:31], s64 offen offset:1024
    buffer_load_dwordx4 v[200:203], v2, s[28:31], s64 offen offset:2048
    buffer_load_dwordx4 v[204:207], v2, s[28:31], s64 offen offset:3072
    s_add_u32 s64, s63, 270336
    buffer_load_dwordx4 v[224:227], v2, s[28:31], s64 offen offset:0
    buffer_load_dwordx4 v[228:231], v2, s[28:31], s64 offen offset:1024
    buffer_load_dwordx4 v[232:235], v2, s[28:31], s64 offen offset:2048
    buffer_load_dwordx4 v[236:239], v2, s[28:31], s64 offen offset:3072
    s_branch K2_DBR1P0
K2_ER1P0:
    s_cmp_eq_u32 s65, 1
    s_cbranch_scc0 K2_DBR1P0
    s_mov_b32 s65, 0
    s_add_u32 s64, s63, 266240
    buffer_load_dwordx4 v[208:211], v2, s[28:31], s64 offen offset:0
    buffer_load_dwordx4 v[212:215], v2, s[28:31], s64 offen offset:1024
    buffer_load_dwordx4 v[216:219], v2, s[28:31], s64 offen offset:2048
    buffer_load_dwordx4 v[220:223], v2, s[28:31], s64 offen offset:3072
    s_add_u32 s64, s63, 274432
    buffer_load_dwordx4 v[240:243], v2, s[28:31], s64 offen offset:0
    buffer_load_dwordx4 v[244:247], v2, s[28:31], s64 offen offset:1024
    buffer_load_dwordx4 v[248:251], v2, s[28:31], s64 offen offset:2048
    buffer_load_dwordx4 v[252:255], v2, s[28:31], s64 offen offset:3072
    s_branch K2_DBR1P0
K2_WR1P1:
    s_waitcnt vmcnt(8)
    s_branch K2_WBR1P1
K2_DR1P1:
    s_cmp_eq_u32 s65, 2
    s_cbranch_scc0 K2_ER1P1
    s_mov_b32 s65, 1
    s_add_u32 s64, s63, 262144
    buffer_load_dwordx4 v[192:195], v2, s[28:31], s64 offen offset:0
    buffer_load_dwordx4 v[196:199], v2, s[28:31], s64 offen offset:1024
    buffer_load_dwordx4 v[200:203], v2, s[28:31], s64 offen offset:2048
    buffer_load_dwordx4 v[204:207], v2, s[28:31], s64 offen offset:3072
    s_add_u32 s64, s63, 270336
    buffer_load_dwordx4 v[224:227], v2, s[28:31], s64 offen offset:0
    buffer_load_dwordx4 v[228:231], v2, s[28:31], s64 offen offset:1024
    buffer_load_dwordx4 v[232:235], v2, s[28:31], s64 offen offset:2048
    buffer_load_dwordx4 v[236:239], v2, s[28:31], s64 offen offset:3072
    s_branch K2_DBR1P1
K2_ER1P1:
    s_cmp_eq_u32 s65, 1
    s_cbranch_scc0 K2_DBR1P1
    s_mov_b32 s65, 0
    s_add_u32 s64, s63, 266240
    buffer_load_dwordx4 v[208:211], v2, s[28:31], s64 offen offset:0
    buffer_load_dwordx4 v[212:215], v2, s[28:31], s64 offen offset:1024
    buffer_load_dwordx4 v[216:219], v2, s[28:31], s64 offen offset:2048
    buffer_load_dwordx4 v[220:223], v2, s[28:31], s64 offen offset:3072
    s_add_u32 s64, s63, 274432
    buffer_load_dwordx4 v[240:243], v2, s[28:31], s64 offen offset:0
    buffer_load_dwordx4 v[244:247], v2, s[28:31], s64 offen offset:1024
    buffer_load_dwordx4 v[248:251], v2, s[28:31], s64 offen offset:2048
    buffer_load_dwordx4 v[252:255], v2, s[28:31], s64 offen offset:3072
    s_branch K2_DBR1P1
K2_T1:
    v_mov_b32 v141, 1
    ds_write_b32 v140, v141
    s_branch K2_T1B
K2_RLATE:
    s_add_u32 s64, s63, 131072
    buffer_load_dwordx4 v[4:7], v2, s[28:31], s64 offen offset:0
    buffer_load_dwordx4 v[8:11], v2, s[28:31], s64 offen offset:1024
    buffer_load_dwordx4 v[12:15], v2, s[28:31], s64 offen offset:2048
    buffer_load_dwordx4 v[16:19], v2, s[28:31], s64 offen offset:3072
    s_add_u32 s64, s63, 135168
    buffer_load_dwordx4 v[20:23], v2, s[28:31], s64 offen offset:0
    buffer_load_dwordx4 v[24:27], v2, s[28:31], s64 offen offset:1024
    buffer_load_dwordx4 v[28:31], v2, s[28:31], s64 offen offset:2048
    buffer_load_dwordx4 v[32:35], v2, s[28:31], s64 offen offset:3072
    s_add_u32 s64, s63, 139264
    buffer_load_dwordx4 v[36:39], v2, s[28:31], s64 offen offset:0
    buffer_load_dwordx4 v[40:43], v2, s[28:31], s64 offen offset:1024
    buffer_load_dwordx4 v[44:47], v2, s[28:31], s64 offen offset:2048
    buffer_load_dwordx4 v[48:51], v2, s[28:31], s64 offen offset:3072
    s_add_u32 s64, s63, 143360
    buffer_load_dwordx4 v[92:95], v2, s[28:31], s64 offen offset:0
    buffer_load_dwordx4 v[96:99], v2, s[28:31], s64 offen offset:1024
    buffer_load_dwordx4 v[100:103], v2, s[28:31], s64 offen offset:2048
    buffer_load_dwordx4 v[104:107], v2, s[28:31], s64 offen offset:3072
    v_and_b32 v152, 15, v1
    v_lshrrev_b32 v153, 4, v1
    v_bfe_u32 v160, v1, 1, 3
    v_xor_b32 v153, v153, v160
    v_lshlrev_b32 v152, 7, v152
    v_add_u32 v152, 65536, v152
    v_lshl_add_u32 v160, v153, 4, v152
    v_xor_b32 v161, 64, v160
    s_waitcnt vmcnt(0) lgkmcnt(0)
    ds_read_b128 v[108:111], v160 offset:0
    ds_read_b128 v[112:115], v161 offset:0
    ds_read_b128 v[116:119], v160 offset:6144
    ds_read_b128 v[120:123], v161 offset:6144
    ds_read_b128 v[124:127], v160 offset:12288
    ds_read_b128 v[128:131], v161 offset:12288
    ds_read_b128 v[132:135], v160 offset:18432
    ds_read_b128 v[136:139], v161 offset:18432
    s_waitcnt lgkmcnt(7)
    v_mfma_f32_16x16x32_bf16 v[168:171], v[108:111], v[4:7], v[168:171]
    v_mfma_f32_16x16x32_bf16 v[172:175], v[108:111], v[36:39], v[172:175]
    ds_read_b128 v[108:111], v160 offset:2048
    s_waitcnt lgkmcnt(7)
    v_mfma_f32_16x16x32_bf16 v[168:171], v[112:115], v[8:11], v[168:171]
    v_mfma_f32_16x16x32_bf16 v[172:175], v[112:115], v[40:43], v[172:175]
    ds_read_b128 v[112:115], v161 offset:2048
    s_waitcnt lgkmcnt(7)
    v_mfma_f32_16x16x32_bf16 v[168:171], v[116:119], v[12:15], v[168:171]
    v_mfma_f32_16x16x32_bf16 v[172:175], v[116:119], v[44:47], v[172:175]
    ds_read_b128 v[116:119], v160 offset:8192
    s_waitcnt lgkmcnt(7)
    v_mfma_f32_16x16x32_bf16 v[168:171], v[120:123], v[16:19], v[168:171]
    v_mfma_f32_16x16x32_bf16 v[172:175], v[120:123], v[48:51], v[172:175]
    ds_read_b128 v[120:123], v161 offset:8192
    s_waitcnt lgkmcnt(7)
    v_mfma_f32_16x16x32_bf16 v[168:171], v[124:127], v[20:23], v[168:171]
    v_mfma_f32_16x16x32_bf16 v[172:175], v[124:127], v[92:95], v[172:175]
    ds_read_b128 v[124:127], v160 offset:14336
    s_waitcnt lgkmcnt(7)
    v_mfma_f32_16x16x32_bf16 v[168:171], v[128:131], v[24:27], v[168:171]
    v_mfma_f32_16x16x32_bf16 v[172:175], v[128:131], v[96:99], v[172:175]
    ds_read_b128 v[128:131], v161 offset:14336
    s_waitcnt lgkmcnt(7)
    v_mfma_f32_16x16x32_bf16 v[168:171], v[132:135], v[28:31], v[168:171]
    v_mfma_f32_16x16x32_bf16 v[172:175], v[132:135], v[100:103], v[172:175]
    ds_read_b128 v[132:135], v160 offset:20480
    s_waitcnt lgkmcnt(7)
    v_mfma_f32_16x16x32_bf16 v[168:171], v[136:139], v[32:35], v[168:171]
    v_mfma_f32_16x16x32_bf16 v[172:175], v[136:139], v[104:107], v[172:175]
    ds_read_b128 v[136:139], v161 offset:20480
    s_waitcnt lgkmcnt(7)
    v_mfma_f32_16x16x32_bf16 v[176:179], v[108:111], v[4:7], v[176:179]
    v_mfma_f32_16x16x32_bf16 v[180:183], v[108:111], v[36:39], v[180:183]
    ds_read_b128 v[108:111], v160 offset:4096
    s_waitcnt lgkmcnt(7)
    v_mfma_f32_16x16x32_bf16 v[176:179], v[112:115], v[8:11], v[176:179]
    v_mfma_f32_16x16x32_bf16 v[180:183], v[112:115], v[40:43], v[180:183]
    ds_read_b128 v[112:115], v161 offset:4096
    s_waitcnt lgkmcnt(7)
    v_mfma_f32_16x16x32_bf16 v[176:179], v[116:119], v[12:15], v[176:179]
    v_mfma_f32_16x16x32_bf16 v[180:183], v[116:119], v[44:47], v[180:183]
    ds_read_b128 v[116:119], v160 offset:10240
    s_waitcnt lgkmcnt(7)
    v_mfma_f32_16x16x32_bf16 v[176:179], v[120:123], v[16:19], v[176:179]
    v_mfma_f32_16x16x32_bf16 v[180:183], v[120:123], v[48:51], v[180:183]
    ds_read_b128 v[120:123], v161 offset:10240
    s_waitcnt lgkmcnt(7)
    v_mfma_f32_16x16x32_bf16 v[176:179], v[124:127], v[20:23], v[176:179]
    v_mfma_f32_16x16x32_bf16 v[180:183], v[124:127], v[92:95], v[180:183]
    ds_read_b128 v[124:127], v160 offset:16384
    s_waitcnt lgkmcnt(7)
    v_mfma_f32_16x16x32_bf16 v[176:179], v[128:131], v[24:27], v[176:179]
    v_mfma_f32_16x16x32_bf16 v[180:183], v[128:131], v[96:99], v[180:183]
    ds_read_b128 v[128:131], v161 offset:16384
    s_waitcnt lgkmcnt(7)
    v_mfma_f32_16x16x32_bf16 v[176:179], v[132:135], v[28:31], v[176:179]
    v_mfma_f32_16x16x32_bf16 v[180:183], v[132:135], v[100:103], v[180:183]
    ds_read_b128 v[132:135], v160 offset:22528
    s_waitcnt lgkmcnt(7)
    v_mfma_f32_16x16x32_bf16 v[176:179], v[136:139], v[32:35], v[176:179]
    v_mfma_f32_16x16x32_bf16 v[180:183], v[136:139], v[104:107], v[180:183]
    ds_read_b128 v[136:139], v161 offset:22528
    s_waitcnt lgkmcnt(7)
    v_mfma_f32_16x16x32_bf16 v[184:187], v[108:111], v[4:7], v[184:187]
    v_mfma_f32_16x16x32_bf16 v[188:191], v[108:111], v[36:39], v[188:191]
    s_waitcnt lgkmcnt(6)
    v_mfma_f32_16x16x32_bf16 v[184:187], v[112:115], v[8:11], v[184:187]
    v_mfma_f32_16x16x32_bf16 v[188:191], v[112:115], v[40:43], v[188:191]
    s_waitcnt lgkmcnt(5)
    v_mfma_f32_16x16x32_bf16 v[184:187], v[116:119], v[12:15], v[184:187]
    v_mfma_f32_16x16x32_bf16 v[188:191], v[116:119], v[44:47], v[188:191]
    s_waitcnt lgkmcnt(4)
    v_mfma_f32_16x16x32_bf16 v[184:187], v[120:123], v[16:19], v[184:187]
    v_mfma_f32_16x16x32_bf16 v[188:191], v[120:123], v[48:51], v[188:191]
    s_waitcnt lgkmcnt(3)
    v_mfma_f32_16x16x32_bf16 v[184:187], v[124:127], v[20:23], v[184:187]
    v_mfma_f32_16x16x32_bf16 v[188:191], v[124:127], v[92:95], v[188:191]
    s_waitcnt lgkmcnt(2)
    v_mfma_f32_16x16x32_bf16 v[184:187], v[128:131], v[24:27], v[184:187]
    v_mfma_f32_16x16x32_bf16 v[188:191], v[128:131], v[96:99], v[188:191]
    s_waitcnt lgkmcnt(1)
    v_mfma_f32_16x16x32_bf16 v[184:187], v[132:135], v[28:31], v[184:187]
    v_mfma_f32_16x16x32_bf16 v[188:191], v[132:135], v[100:103], v[188:191]
    s_waitcnt lgkmcnt(0)
    v_mfma_f32_16x16x32_bf16 v[184:187], v[136:139], v[32:35], v[184:187]
    v_mfma_f32_16x16x32_bf16 v[188:191], v[136:139], v[104:107], v[188:191]
    s_nop 7
    s_branch K2_RLATE_BACK
K2_SLOW:
    s_waitcnt vmcnt(0)
    s_barrier
    s_mov_b64 s[44:45], s[70:71]
    s_load_dwordx4 s[68:71], s[0:1], 8
    s_load_dwordx4 s[72:75], s[0:1], 24
    v_lshlrev_b32 v4, 4, v1
    v_mov_b32 v8, 0
    v_mov_b32 v9, 0
    v_mov_b32 v10, 0
    v_mov_b32 v11, 0
    s_lshl_b32 s64, s3, 10
    v_add_u32 v5, s64, v4
    ds_write_b128 v5, v[8:11] offset:0
    ds_write_b128 v5, v[8:11] offset:8192
    ds_write_b128 v5, v[8:11] offset:16384
    ds_write_b128 v5, v[8:11] offset:24576
    ds_write_b128 v5, v[8:11] offset:32768
    v_lshrrev_b32 v5, 4, v1
    v_and_b32 v6, 15, v1
    v_lshlrev_b32 v5, 7, v5
    v_lshl_add_u32 v5, v6, 2, v5
    v_add_u32 v5, 262144, v5
    s_waitcnt lgkmcnt(0)
    s_mov_b32 s16, s68
    s_mov_b32 s17, s69
    s_mov_b32 s18, 0x138800
    s_mov_b32 s19, 0x20000
    s_mov_b32 s20, s70
    s_mov_b32 s21, s71
    s_mov_b32 s22, 0x9c400
    s_mov_b32 s23, 0x20000
    s_mov_b32 s24, s72
    s_mov_b32 s25, s73
    s_mov_b32 s26, 0x9c400
    s_mov_b32 s27, 0x20000
    s_mov_b32 s36, s74
    s_mov_b32 s37, s75
    s_mov_b32 s38, 0x40800
    s_mov_b32 s39, 0x20000
    s_mov_b32 s40, s14
    s_mov_b32 s41, s15
    s_mov_b32 s42, 0x4e2000
    s_mov_b32 s43, 0x20000
    buffer_load_dword v12, v5, s[36:39], 0 offen offset:0
    buffer_load_dword v13, v5, s[36:39], 0 offen offset:64
    buffer_load_dword v14, v5, s[36:39], 0 offen offset:512
    buffer_load_dword v15, v5, s[36:39], 0 offen offset:576
    buffer_load_dword v16, v5, s[36:39], 0 offen offset:1024
    buffer_load_dword v17, v5, s[36:39], 0 offen offset:1088
    buffer_load_dword v18, v5, s[36:39], 0 offen offset:1536
    buffer_load_dword v19, v5, s[36:39], 0 offen offset:1600
    s_waitcnt vmcnt(0)
    v_lshlrev_b32 v20, 16, v12
    v_lshlrev_b32 v21, 16, v13
    v_and_b32 v22, 0xffff0000, v12
    v_and_b32 v23, 0xffff0000, v13
    v_lshlrev_b32 v24, 16, v14
    v_lshlrev_b32 v25, 16, v15
    v_and_b32 v26, 0xffff0000, v14
    v_and_b32 v27, 0xffff0000, v15
    v_lshlrev_b32 v28, 16, v16
    v_lshlrev_b32 v29, 16, v17
    v_and_b32 v30, 0xffff0000, v16
    v_and_b32 v31, 0xffff0000, v17
    v_lshlrev_b32 v32, 16, v18
    v_lshlrev_b32 v33, 16, v19
    v_and_b32 v34, 0xffff0000, v18
    v_and_b32 v35, 0xffff0000, v19
    v_mul_f32 v20, 0xbfb8aa3b, v20
    v_mul_f32 v21, 0xbfb8aa3b, v21
    v_mul_f32 v22, 0xbfb8aa3b, v22
    v_mul_f32 v23, 0xbfb8aa3b, v23
    v_mul_f32 v24, 0xbfb8aa3b, v24
    v_mul_f32 v25, 0xbfb8aa3b, v25
    v_mul_f32 v26, 0xbfb8aa3b, v26
    v_mul_f32 v27, 0xbfb8aa3b, v27
    v_mul_f32 v28, 0xbfb8aa3b, v28
    v_mul_f32 v29, 0xbfb8aa3b, v29
    v_mul_f32 v30, 0xbfb8aa3b, v30
    v_mul_f32 v31, 0xbfb8aa3b, v31
    v_mul_f32 v32, 0xbfb8aa3b, v32
    v_mul_f32 v33, 0xbfb8aa3b, v33
    v_mul_f32 v34, 0xbfb8aa3b, v34
    v_mul_f32 v35, 0xbfb8aa3b, v35
    s_mul_i32 s68, s2, 625
    s_lshr_b32 s68, s68, 4
    v_lshlrev_b32 v6, 2, v1
    v_lshlrev_b32 v7, 3, v1
    s_mov_b32 s69, 0
K2_SL_SCAN:
    buffer_load_dword v12, v6, s[24:27], 0 offen
    s_waitcnt vmcnt(0)
    v_subrev_u32 v12, s68, v12
    v_and_b32 v13, 7, v12
    v_cmp_gt_u32 vcc, s44, v12
    v_cmp_eq_u32 s[70:71], s3, v13
    s_and_b64 s[70:71], s[70:71], vcc
    s_cbranch_scc0 K2_SL_NEXT
    v_lshlrev_b32 v13, 1, v6
    buffer_load_dword v14, v6, s[20:23], 0 offen
    buffer_load_dwordx2 v[16:17], v13, s[16:19], 0 offen
    s_waitcnt vmcnt(0)
K2_SL_EDGE:
    s_ff1_i32_b64 s72, s[70:71]
    s_bitset0_b64 s[70:71], s72
    v_readlane_b32 s73, v12, s72
    v_readlane_b32 s74, v14, s72
    v_readlane_b32 s75, v16, s72
    v_readlane_b32 s76, v17, s72
    s_lshl_b32 s74, s74, 9
    s_and_b32 s77, s73, 3
    s_lshl_b32 s77, s77, 6
    s_bfe_u32 s78, s73, 0x20002
    s_lshl_b32 s78, s78, 4
    s_or_b32 s77, s77, s78
    s_lshl_b32 s78, s73, 9
    v_add_u32 v13, s74, v7
    buffer_load_dwordx2 v[36:37], v13, s[40:43], 0 offen
    s_add_u32 s78, s78, 90112
    v_xor_b32 v13, s77, v7
    v_add_u32 v13, s78, v13
    ds_read_b64 v[38:39], v13
    s_lshl_b32 s78, s73, 10
    v_add_u32 v15, s78, v4
    ds_read_b128 v[40:43], v15 offset:0
    s_lshl_b32 s77, s75, 16
    s_and_b32 s75, s75, 0xffff0000
    s_lshl_b32 s78, s76, 16
    s_and_b32 s76, s76, 0xffff0000
    s_waitcnt vmcnt(0) lgkmcnt(0)
    v_lshlrev_b32 v44, 16, v36
    v_and_b32 v45, 0xffff0000, v36
    v_lshlrev_b32 v48, 16, v38
    v_and_b32 v49, 0xffff0000, v38
    v_add_f32 v44, v44, v48
    v_add_f32 v45, v45, v49
    v_lshlrev_b32 v46, 16, v37
    v_and_b32 v47, 0xffff0000, v37
    v_lshlrev_b32 v48, 16, v39
    v_and_b32 v49, 0xffff0000, v39
    v_add_f32 v46, v46, v48
    v_add_f32 v47, v47, v49
    v_fmac_f32 v44, s77, v20
    v_fmac_f32 v45, s77, v21
    v_fmac_f32 v46, s77, v22
    v_fmac_f32 v47, s77, v23
    v_fmac_f32 v44, s75, v24
    v_fmac_f32 v45, s75, v25
    v_fmac_f32 v46, s75, v26
    v_fmac_f32 v47, s75, v27
    v_fmac_f32 v44, s78, v28
    v_fmac_f32 v45, s78, v29
    v_fmac_f32 v46, s78, v30
    v_fmac_f32 v47, s78, v31
    v_fmac_f32 v44, s76, v32
    v_fmac_f32 v45, s76, v33
    v_fmac_f32 v46, s76, v34
    v_fmac_f32 v47, s76, v35
    v_exp_f32 v48, v44
    v_exp_f32 v49, v45
    v_exp_f32 v50, v46
    v_exp_f32 v51, v47
    v_add_f32 v48, 1.0, v48
    v_add_f32 v49, 1.0, v49
    v_add_f32 v50, 1.0, v50
    v_add_f32 v51, 1.0, v51
    v_rcp_f32 v48, v48
    v_rcp_f32 v49, v49
    v_rcp_f32 v50, v50
    v_rcp_f32 v51, v51
    v_fmac_f32 v40, v44, v48
    v_fmac_f32 v41, v45, v49
    v_fmac_f32 v42, v46, v50
    v_fmac_f32 v43, v47, v51
    ds_write_b128 v15, v[40:43] offset:0
    s_cmp_lg_u64 s[70:71], 0
    s_cbranch_scc1 K2_SL_EDGE
K2_SL_NEXT:
    v_add_u32 v6, 256, v6
    s_add_u32 s69, s69, 1
    s_cmp_lt_u32 s69, 2500
    s_cbranch_scc1 K2_SL_SCAN
    v_lshrrev_b32 v5, 5, v1
    v_and_b32 v6, 31, v1
    v_lshlrev_b32 v5, 8, v5
    v_lshl_add_u32 v5, v6, 2, v5
    v_lshlrev_b32 v6, 2, v1
    s_mov_b32 s69, s3
K2_SL_CVT:
    s_lshl_b32 s70, s69, 10
    v_add_u32 v7, s70, v5
    ds_read_b32 v8, v7 offset:0
    ds_read_b32 v9, v7 offset:128
    ds_read_b32 v10, v7 offset:512
    ds_read_b32 v11, v7 offset:640
    s_and_b32 s70, s69, 15
    s_lshl_b32 s70, s70, 4
    v_xor_b32 v7, s70, v6
    s_lshl_b32 s70, s69, 9
    s_add_u32 s70, s70, 110592
    v_add_u32 v7, s70, v7
    s_waitcnt lgkmcnt(0)
    v_cvt_pk_bf16_f32 v8, v8, v9
    ds_write_b32 v7, v8 offset:0
    v_cvt_pk_bf16_f32 v10, v10, v11
    ds_write_b32 v7, v10 offset:256
    s_add_u32 s69, s69, 8
    s_cmp_lt_u32 s69, 40
    s_cbranch_scc1 K2_SL_CVT
    s_mov_b32 s71, s45
    s_waitcnt lgkmcnt(0)
    s_barrier
    s_branch K2_SLOW_BACK
FK_CODE_END:
.section .rodata,"a"
.p2align 6
.amdhsa_kernel standalone__mpnn_edge_mlp__graph_kernel
  .amdhsa_next_free_vgpr 256
  .amdhsa_next_free_sgpr 102
  .amdhsa_accum_offset 256
  .amdhsa_group_segment_fixed_size 0
  .amdhsa_kernarg_size 72
  .amdhsa_user_sgpr_count 2
  .amdhsa_user_sgpr_kernarg_segment_ptr 1
  .amdhsa_system_sgpr_workgroup_id_x 1
  .amdhsa_float_denorm_mode_32 3
.end_amdhsa_kernel
```
